```python
import torch

def _softmax(x, axis=-1):
    return torch.softmax(x, dim=axis)
def _gelu(x):
    return torch.nn.functional.gelu(x, approximate="tanh")
def _silu(x):
    return torch.nn.functional.silu(x)
def _sigmoid(x):
    return torch.sigmoid(x)
def _layernorm(x, axis=-1, eps=1e-5):
    m = x.mean(dim=axis, keepdim=True)
    v = x.var(dim=axis, keepdim=True, unbiased=False)
    return (x - m) / torch.sqrt(v + eps)
def _scatter_add(tgt, idx, src, axis=0):
    return tgt.clone().index_add_(axis, idx, src)
def _segment_sum(src, seg, n):
    out = torch.zeros((n,) + src.shape[1:], dtype=src.dtype)
    return out.index_add_(0, seg, src)
def _pad(x, pw):
    flat = tuple(v for pair in reversed(pw) for v in pair)
    return torch.nn.functional.pad(x, flat)

kernel_name = 'standalone__paged_block_table_kv_pagedattention__sampling'

def setup_inputs():

    _w = (lambda a: (lambda t: t.to(torch.bfloat16) if t.is_floating_point() else t)(torch.as_tensor(a)))
    B, Hq, Hkv, Sq, Skv, D = 16, 16, 8, 16, 2048, 256
    bs = 16
    nbps = max(1, Skv // bs)
    num_phys = B * nbps + 4
    bt = torch.randperm(num_phys)[: B * nbps].reshape(B, nbps).to(torch.int64)
    cl = (nbps * bs - (torch.arange(1, B + 1, dtype=torch.int64) * 2654435761) % max(1, nbps * bs // 2)).to(torch.int64)
    return {
        "q": _w((lambda *s: torch.randn(*s, dtype=torch.bfloat16) * 0.8)(B, Hq, Sq, D)),
        "k_cache": _w((lambda *s: torch.randn(*s, dtype=torch.bfloat16) * 0.8)(num_phys, bs, Hkv, D)),
        "v_cache": _w((lambda *s: torch.randn(*s, dtype=torch.bfloat16) * 0.05)(num_phys, bs, Hkv, D)),
        "block_table": _w(bt),
        "context_lens": _w(cl),
    }

def reference(q, k_cache, v_cache, block_table, context_lens):
    B, Hq, Sq, D = q.shape
    bs = k_cache.shape[1]
    Hkv = k_cache.shape[2]
    nbps = block_table.shape[1]
    Skv = nbps * bs
    bt = block_table.reshape(-1)
    k = (lambda x, *d: x.permute(*d))(k_cache[bt].reshape(B, Skv, Hkv, D), 0, 2, 1, 3)
    v = (lambda x, *d: x.permute(*d))(v_cache[bt].reshape(B, Skv, Hkv, D), 0, 2, 1, 3)
    g = Hq // Hkv
    qg = q.reshape(B, Hkv, g, Sq, D)
    scores = torch.einsum("bhgqd,bhkd->bhgqk", qg, k) * (D ** -0.5)
    pos = torch.arange(Skv)
    msk = pos[None, :] < context_lens[:, None]
    scores = torch.where(msk[:, None, None, None, :], scores, -1e9)
    p = _softmax(scores, axis=-1)
    out = torch.einsum("bhgqk,bhkd->bhgqd", p, v)
    return out.reshape(B, Hq, Sq, D)
```

```asm
; @launch grid=(256,1,1) block=(256,1,1) lds=131328
.amdgcn_target "amdgcn-amd-amdhsa--gfx950"
.text
.globl standalone__paged_block_table_kv_pagedattention__sampling_kernel
.p2align 8
.type standalone__paged_block_table_kv_pagedattention__sampling_kernel,@function
standalone__paged_block_table_kv_pagedattention__sampling_kernel:
    s_cmpk_ge_u32 s2, 0x100
    s_cbranch_scc1 L_end
    s_load_dwordx4 s[12:15], s[0:1], 24
    s_getpc_b64 s[80:81]
    v_mad_u64_u32 v[240:241], vcc, v0, 40, s[80:81]
    global_load_dword v203, v[240:241], off
    s_lshr_b32 s46, s2, 3
    s_and_b32 s69, s46, 15
    s_mov_b32 s78, 0x7b547290
    s_mov_b32 s79, 0xee4cb092
    s_lshl_b32 s57, s69, 2
    s_lshr_b64 s[78:79], s[78:79], s57
    s_and_b32 s54, s78, 15
    s_cmp_lt_u32 s46, 16
    s_cselect_b32 s54, s69, s54
    s_lshl_b32 s57, s54, 9
    v_lshrrev_b32 v17, 7, v0
    v_lshrrev_b32 v16, 6, v0
    v_and_b32 v0, 63, v0
    v_lshlrev_b32 v17, 2, v17
    v_lshl_add_u32 v202, v0, 3, v17
    v_and_b32 v52, 15, v0
    v_add_u32 v201, s57, v202
    v_lshlrev_b32 v192, 2, v52
    s_waitcnt lgkmcnt(0)
    global_load_dword v201, v201, s[12:13]
    global_load_dword v192, v192, s[14:15]
    s_load_dwordx2 s[28:29], s[0:1], 0
    s_load_dwordx2 s[20:21], s[0:1], 8
    s_load_dwordx2 s[24:25], s[0:1], 16
    s_lshl_b32 s58, s69, 9
    v_add_u32 v202, s58, v202
    v_readfirstlane_b32 s44, v16
    global_load_dword v202, v202, s[12:13]
    s_cmp_lt_u32 s46, 16
    s_cselect_b32 s45, 6, 10
    s_cselect_b32 s64, 1, 0
    s_add_u32 s45, s45, s2
    s_and_b32 s45, s45, 7
    s_mov_b32 s30, 0x200000
    s_mov_b32 s31, 0x00020000
    s_mov_b32 s22, 0x8040000
    s_mov_b32 s23, 0x00020000
    s_mov_b32 s26, 0x8040000
    s_mov_b32 s27, 0x00020000
    s_and_b32 s58, s44, 1
    s_lshl1_add_u32 s72, s45, s58
    s_lshl_b32 s72, s72, 13
    v_lshrrev_b32 v20, 5, v0
    v_and_b32 v21, 31, v0
    v_lshl_add_u32 v7, s44, 3, v20
    s_lshl_b32 s61, s44, 12
    v_and_b32 v22, 15, v7
    s_lshl_b32 s57, s45, 14
    v_lshl_add_u32 v19, v7, 9, s57
    v_xor_b32 v18, v21, v22
    v_lshl_add_u32 v8, v18, 4, v19
    s_waitcnt lgkmcnt(0)
    s_add_u32 m0, s61, 98304
    s_lshl_b32 s60, s54, 17
    v_xor_b32 v243, 32, v8
    v_xor_b32 v244, 64, v8
    v_xor_b32 v245, 96, v8
    buffer_load_dwordx4 v8, s[28:31], s60 offen offset:0 lds
    buffer_load_dwordx4 v243, s[28:31], s60 offen offset:1024 lds
    buffer_load_dwordx4 v244, s[28:31], s60 offen offset:2048 lds
    buffer_load_dwordx4 v245, s[28:31], s60 offen offset:3072 lds
    s_lshl_b32 s57, s69, 1
    s_lshr_b32 s56, 0x4a622155, s57
    s_and_b32 s56, s56, 3
    s_add_u32 s56, s56, 46
    s_bitcmp1_b32 0x5ab5, s69
    s_cselect_b32 s75, -1, 1
    s_cmp_lt_u32 s46, 16
    s_cselect_b32 s56, 0, s56
    s_cselect_b32 s75, 1, s75
    s_lshl_b32 s57, s45, 9
    v_lshl_add_u32 v23, v22, 12, s57
    v_xor_b32 v22, v21, v22
    v_lshl_add_u32 v32, v22, 4, v23
    v_lshlrev_b32 v20, 1, v20
    v_xor_b32 v20, v21, v20
    v_lshl_add_u32 v36, v20, 4, v23
    v_xor_b32 v33, 32, v32
    v_xor_b32 v37, 64, v36
    v_add_u32 v33, 7168, v33
    v_add_u32 v37, 7168, v37
    v_xor_b32 v34, 64, v32
    v_xor_b32 v38, 128, v36
    v_add_u32 v34, 14336, v34
    v_add_u32 v38, 14336, v38
    v_xor_b32 v35, 96, v32
    v_xor_b32 v39, 192, v36
    v_add_u32 v35, 21504, v35
    v_add_u32 v39, 21504, v39
    s_movk_i32 s57, 433
    v_mad_u32_u24 v11, v52, s57, s57
    v_and_b32 v11, 0x3ff, v11
    v_sub_u32 v11, 0x800, v11
    s_mov_b32 s50, 0
    s_mov_b32 s51, 0
    v_readlane_b32 s74, v11, s54
    s_waitcnt vmcnt(5)
    v_cmp_ne_u32 vcc, v192, v11
    s_cbranch_vccnz L_general
L_first:
    v_readlane_b32 s57, v201, s56
    s_lshl_b32 s58, s56, 5
    s_sub_u32 s58, s74, s58
    s_add_u32 s59, s51, s61
    s_mov_b32 m0, s59
    s_lshl_b32 s57, s57, 16
    s_add_u32 s59, s59, 16384
    s_cmp_lt_u32 s58, 32
    s_cbranch_scc1 L_ldslow_1
    buffer_load_dwordx4 v32, s[20:23], s57 offen offset:0 nt lds
    buffer_load_dwordx4 v33, s[20:23], s57 offen offset:1024 nt lds
    buffer_load_dwordx4 v34, s[20:23], s57 offen offset:2048 nt lds
    buffer_load_dwordx4 v35, s[20:23], s57 offen offset:3072 nt lds
    s_mov_b32 m0, s59
    s_nop 0
    buffer_load_dwordx4 v36, s[24:27], s57 offen offset:0 nt lds
    buffer_load_dwordx4 v37, s[24:27], s57 offen offset:1024 nt lds
    buffer_load_dwordx4 v38, s[24:27], s57 offen offset:2048 nt lds
    buffer_load_dwordx4 v39, s[24:27], s57 offen offset:3072 nt lds
L_ldgo_2:
    s_add_u32 s50, s50, 1
    s_add_u32 s51, s51, 32768
    s_add_u32 s56, s56, s75
    s_cmp_lt_u32 s50, 2
    s_cbranch_scc1 L_first
    s_mov_b32 s77, 1
    v_add_u32 v54, 31, v11
    v_lshrrev_b32 v54, 5, v54
    v_cmp_gt_u32 vcc, 8, v52
    v_mov_b32 v16, 0x18001d00
    v_mov_b32 v17, 0x270000
    v_mov_b32 v18, 0x3
    v_mov_b32 v19, 0x35000b00
    v_lshlrev_b32 v20, 3, v52
    v_cndmask_b32 v16, v18, v16, vcc
    v_cndmask_b32 v17, v19, v17, vcc
    v_lshrrev_b64 v[16:17], v20, v[16:17]
    v_and_b32 v31, 0xff, v16
    s_mov_b32 s58, 0x5b956666
    v_lshlrev_b32 v52, 1, v52
    v_bfe_u32 v52, s58, v52, 2
    v_add_u32 v52, 46, v52
L_shares:
    v_sub_u32 v10, v54, v52 clamp
    v_sub_u32 v56, v52, v54 clamp
    v_min_u32 v55, v54, v52
    v_mov_b32 v9, v10
    v_mov_b32 v255, v56
    v_add_u32 v57, 4, v52
    v_add_u32_dpp v9, v9, v9 row_shr:1 row_mask:0xf bank_mask:0xf bound_ctrl:1
    v_add_u32_dpp v255, v255, v255 row_shr:1 row_mask:0xf bank_mask:0xf bound_ctrl:1
    v_lshrrev_b32 v57, 1, v57
    v_add_u32_dpp v9, v9, v9 row_shr:2 row_mask:0xf bank_mask:0xf bound_ctrl:1
    v_add_u32_dpp v255, v255, v255 row_shr:2 row_mask:0xf bank_mask:0xf bound_ctrl:1
    v_min_u32 v57, v57, v55
    v_add_u32_dpp v9, v9, v9 row_shr:4 row_mask:0xf bank_mask:0xf bound_ctrl:1
    v_add_u32_dpp v255, v255, v255 row_shr:4 row_mask:0xf bank_mask:0xf bound_ctrl:1
    v_sub_u32 v58, v55, v57
    v_add_u32_dpp v9, v9, v9 row_shr:8 row_mask:0xf bank_mask:0xf bound_ctrl:1
    v_add_u32_dpp v255, v255, v255 row_shr:8 row_mask:0xf bank_mask:0xf bound_ctrl:1
    v_subrev_u32 v59, 15, v57
    v_subrev_u32 v21, 1, v58
    v_add3_u32 v22, v56, v58, -16
    v_min3_i32 v59, v59, v21, v22
    v_med3_i32 v59, v59, 0, 5
    s_cmp_lg_u32 s77, 0
    s_cbranch_scc1 L_ranges
    v_sub_u32 v31, v255, v56
L_ranges:
    v_add_u32 v255, v31, v56
    v_cmp_lt_u32 vcc, 0, v58
    s_and_b32 s54, s46, 15
    v_readlane_b32 s53, v59, s54
    v_readlane_b32 s74, v11, s54
    s_and_b32 s14, vcc_lo, 0xffff
    s_mov_b64 s[62:63], 0
    v_mov_b32 v22, s54
    v_mov_b32 v23, s74
    s_cmp_eq_u32 s64, 0
    s_cbranch_scc1 L_sched_helper
    v_readlane_b32 s47, v57, s54
    v_mov_b32 v21, v0
    s_mov_b32 s15, 7
    s_branch L_sched_zone
L_sched_helper:
    v_readlane_b32 s57, v31, s54
    v_readlane_b32 s58, v255, s54
    v_readlane_b32 s47, v58, s54
    v_readlane_b32 s59, v55, s54
    s_sub_u32 s60, s58, s57
    s_add_u32 s47, s47, s60
    s_cmp_eq_u32 s47, 0
    s_cbranch_scc1 L_end
    s_add_u32 s59, s59, s60
    s_sub_u32 s59, s59, 1
    v_sub_u32 v21, s59, v0
    s_mov_b32 s15, 4
    s_cmp_eq_u32 s60, 0
    s_cbranch_scc1 L_sched_zone
    v_cmp_ge_u32 vcc, s57, v9
    v_add_u32 v20, s57, v0
    v_cmp_gt_u32 s[78:79], s60, v0
    s_nop 0
    s_and_b32 s54, vcc_lo, 0xffff
    s_bcnt1_i32_b32 s54, s54
    s_mov_b32 s56, s54
    s_mov_b64 exec, s[78:79]
L_sched_piece:
    v_readlane_b32 s59, v9, s56
    v_readlane_b32 s60, v10, s56
    v_readlane_b32 s74, v11, s56
    v_readlane_b32 s52, v55, s56
    s_sub_u32 s75, s59, s60
    v_cmp_le_u32 vcc, s75, v20
    s_sub_u32 s75, s52, s75
    v_add_u32 v240, s75, v20
    v_mov_b32 v241, s56
    v_mov_b32 v242, s74
    v_cndmask_b32 v21, v21, v240, vcc
    v_cndmask_b32 v22, v22, v241, vcc
    v_cndmask_b32 v23, v23, v242, vcc
    s_min_u32 s75, s59, s58
    s_sub_u32 s75, s75, s57
    s_sub_u32 s75, s75, 1
    s_bitset1_b64 s[62:63], s75
    s_add_u32 s56, s56, 1
    s_cmp_lt_u32 s59, s58
    s_cbranch_scc1 L_sched_piece
    s_mov_b64 exec, -1
L_sched_zone:
    s_sub_u32 s47, s47, s53
    s_lshl_b32 s53, s53, 1
    s_add_u32 s52, s47, s53
    s_sub_u32 s5, s47, s15
    s_sub_u32 s15, s52, s15
    s_cmp_lg_u32 s53, 0
    s_cbranch_scc1 L_sched_done
    s_mov_b32 s5, 0x7fffffff
    s_sub_u32 s57, s47, 1
    s_bitset1_b64 s[62:63], s57
L_sched_done:
    s_load_dwordx2 s[32:33], s[0:1], 40
    s_load_dwordx2 s[36:37], s[0:1], 48
    s_load_dwordx2 s[40:41], s[0:1], 56
    v_min_u32 v21, 63, v21
    s_cmp_eq_u32 s77, 0
    s_cbranch_scc1 L_list
    v_lshlrev_b32 v240, 2, v21
    s_waitcnt vmcnt(20)
    ds_bpermute_b32 v2, v240, v201
    ds_bpermute_b32 v202, v240, v202
    v_cmp_eq_u32 vcc, s54, v22
    s_waitcnt lgkmcnt(0)
    v_cndmask_b32 v2, v202, v2, vcc
L_listed:
    v_and_b32 v241, 0xfff, v23
    v_lshlrev_b32 v21, 5, v21
    v_sub_u32 v241, v241, v21 clamp
    v_min_u32 v241, 32, v241
    v_and_b32 v23, 0x2000, v23
    v_lshl_or_b32 v1, v22, 8, v241
    v_or_b32 v1, v1, v23
    s_mov_b32 s34, 0x200000
    s_mov_b32 s35, 0x00020000
    s_mov_b32 s38, 0x100
    s_mov_b32 s39, 0x00020000
    s_mov_b32 s42, 0x20100000
    s_mov_b32 s43, 0x00020000
    v_and_b32 v17, 15, v0
    v_lshrrev_b32 v18, 4, v0
    s_lshr_b32 s59, s44, 1
    s_mul_i32 s73, s45, 1392640
    s_mul_i32 s60, s44, 4352
    s_add_u32 s73, s73, s60
    v_lshlrev_b32 v13, 4, v0
    v_lshlrev_b32 v15, 2, v0
    v_lshlrev_b32 v6, 2, v18
    v_lshlrev_b32 v19, 9, v17
    v_and_b32 v20, 1, v18
    v_lshrrev_b32 v21, 1, v18
    v_lshl_add_u32 v14, v20, 5, v19
    v_lshl_add_u32 v14, v21, 4, v14
    s_lshl_b32 s60, s59, 8
    v_add_u32 v14, s60, v14
    v_or_b32 v20, 0, v18
    v_xor_b32 v20, v20, v17
    v_lshl_add_u32 v40, v20, 4, v19
    v_or_b32 v20, 4, v18
    v_xor_b32 v20, v20, v17
    v_lshl_add_u32 v41, v20, 4, v19
    v_or_b32 v20, 8, v18
    v_xor_b32 v20, v20, v17
    v_lshl_add_u32 v42, v20, 4, v19
    v_or_b32 v20, 12, v18
    v_xor_b32 v20, v20, v17
    v_lshl_add_u32 v43, v20, 4, v19
    v_lshrrev_b32 v20, 2, v17
    v_add_u32 v20, v20, v6
    v_and_b32 v21, 7, v20
    v_lshlrev_b32 v21, 5, v21
    v_lshl_add_u32 v21, v20, 9, v21
    v_and_b32 v22, 3, v0
    v_lshl_add_u32 v21, v22, 3, v21
    s_add_u32 s60, s60, 16384
    v_add_u32 v21, s60, v21
    v_xor_b32 v44, 0, v21
    v_xor_b32 v45, 32, v21
    v_xor_b32 v46, 64, v21
    v_xor_b32 v47, 96, v21
    v_xor_b32 v48, 128, v21
    v_xor_b32 v49, 160, v21
    v_xor_b32 v50, 192, v21
    v_xor_b32 v51, 224, v21
    v_mov_b32 v64, 0
    v_mov_b32 v65, 0
    v_mov_b32 v66, 0
    v_mov_b32 v67, 0
    v_mov_b32 v68, 0
    v_mov_b32 v69, 0
    v_mov_b32 v70, 0
    v_mov_b32 v71, 0
    v_mov_b32 v72, 0
    v_mov_b32 v73, 0
    v_mov_b32 v74, 0
    v_mov_b32 v75, 0
    v_mov_b32 v76, 0
    v_mov_b32 v77, 0
    v_mov_b32 v78, 0
    v_mov_b32 v79, 0
    v_mov_b32 v80, 0
    v_mov_b32 v81, 0
    v_mov_b32 v82, 0
    v_mov_b32 v83, 0
    v_mov_b32 v84, 0
    v_mov_b32 v85, 0
    v_mov_b32 v86, 0
    v_mov_b32 v87, 0
    v_mov_b32 v88, 0
    v_mov_b32 v89, 0
    v_mov_b32 v90, 0
    v_mov_b32 v91, 0
    v_mov_b32 v92, 0
    v_mov_b32 v93, 0
    v_mov_b32 v94, 0
    v_mov_b32 v95, 0
    v_mov_b32 v3, 0xff61b1e6
    v_mov_b32 v5, 0
    s_mov_b32 s48, 0
    s_mov_b32 s49, 0
    s_mov_b32 s71, 0
    s_mov_b32 s66, 0
    s_mov_b32 s65, 0
    s_mov_b32 s70, 0
    s_mov_b32 s67, 0x7fffffff
    s_mov_b32 s4, 0
    s_mov_b32 s6, 0
    s_mov_b32 s7, -1
    s_mov_b64 s[8:9], 0
    s_mov_b64 s[16:17], 0
    v_mov_b32 v251, 0x20000
    s_mov_b32 s101, 0
    s_mov_b32 s10, 114688
    s_cmp_eq_u32 s77, 0
    s_cbranch_scc1 L_pro_load
L_pro_loaded:
    s_ff1_i32_b64 s57, s[62:63]
    s_sub_u32 s58, s47, 1
    s_cmp_ge_u32 s57, s58
    s_cbranch_scc1 L_no_q2
    s_add_u32 s57, s57, 1
    v_readlane_b32 s58, v1, s57
    s_bfe_u32 s58, s58, 0x40008
    s_add_u32 m0, s61, s10
    s_lshl_b32 s60, s58, 17
    v_xor_b32 v243, 32, v8
    v_xor_b32 v244, 64, v8
    v_xor_b32 v245, 96, v8
    buffer_load_dwordx4 v8, s[28:31], s60 offen offset:0 lds
    buffer_load_dwordx4 v243, s[28:31], s60 offen offset:1024 lds
    buffer_load_dwordx4 v244, s[28:31], s60 offen offset:2048 lds
    buffer_load_dwordx4 v245, s[28:31], s60 offen offset:3072 lds
    s_mov_b32 s101, 4
L_no_q2:
    s_mov_b32 s68, 0
    v_readlane_b32 s56, v1, 0
    s_bitcmp1_b32 s56, 13
    s_cselect_b32 s55, 0, 0x3db8aa3b
    v_mul_f32 v4, s55, v3
    s_and_b32 s60, s46, 15
    s_lshl3_add_u32 s57, s60, s45
    s_mul_i32 s76, s57, 256
    s_add_u32 s76, s76, 0xc00000
    v_bfe_u32 v193, v1, 8, 4
    v_lshl_add_u32 v193, v193, 3, s45
    v_and_b32 v200, 1, v193
    v_lshlrev_b32 v200, 4, v200
    v_lshrrev_b32 v197, 1, v193
    v_lshlrev_b32 v197, 2, v197
    v_mul_u32_u24 v193, 256, v193
    v_add_u32 v193, 0xc00000, v193
    v_mov_b32 v194, 1
    v_mov_b32 v198, 0
    s_mov_b64 s[0:1], s[62:63]
    s_bitset1_b64 s[0:1], 63
    s_mov_b32 s19, 1
    s_mov_b32 s77, 0
    s_cmp_lg_u32 s44, 0
    s_cbranch_scc1 L_pro_w
    s_mov_b32 s6, 1
    buffer_load_dword v195, v193, s[40:43], 0 offen sc1
L_pro_w:
    s_cmp_eq_u32 s64, 0
    s_cselect_b32 s3, 1, 3
    s_cselect_b32 s57, 7, 1
    s_and_b32 s3, s3, s46
    s_add_u32 s3, s3, s57
    s_cmp_eq_u32 s64, 0
    s_cbranch_scc1 L_pro_end
    v_readlane_b32 s57, v9, s54
    v_readlane_b32 s58, v10, s54
    s_lshr_b32 s59, s14, s54
    s_sub_u32 s58, s57, s58
    v_max_u32 v16, s58, v31
    v_min_u32 v17, s57, v255
    v_cmp_lt_u32 vcc, v16, v17
    s_and_b32 s59, s59, 1
    s_lshl_b32 s59, s59, 17
    s_nop 1
    s_and_b32 s65, vcc_lo, 0xffff
    s_or_b32 s65, s65, s59
    s_bcnt1_i32_b32 s66, s65
    s_cmp_eq_u32 s66, 0
    s_cbranch_scc1 L_pro_end
    s_cmp_lg_u32 s53, 0
    s_cbranch_scc1 L_pro_end
    s_sub_i32 s67, s47, 2
L_pro_end:
    s_lshl3_add_u32 s57, s50, s6
    s_add_u32 s57, s57, s101
    s_cmp_lt_u32 s57, 21
    s_cbranch_scc1 L_wq_3
    s_waitcnt vmcnt(21)
    s_branch L_q_in
L_wq_3:
    s_cmp_lt_u32 s57, 20
    s_cbranch_scc1 L_wq_4
    s_waitcnt vmcnt(20)
    s_branch L_q_in
L_wq_4:
    s_cmp_lt_u32 s57, 17
    s_cbranch_scc1 L_wq_5
    s_waitcnt vmcnt(17)
    s_branch L_q_in
L_wq_5:
    s_cmp_lt_u32 s57, 16
    s_cbranch_scc1 L_wq_6
    s_waitcnt vmcnt(16)
    s_branch L_q_in
L_wq_6:
    s_waitcnt vmcnt(8)
L_q_in:
    s_mov_b32 s58, 98304
    s_barrier
    s_and_b32 s60, s72, 0x2000
    s_add_u32 s58, s58, s60
    v_add_u32 v20, s58, v40
    v_add_u32 v21, s58, v41
    v_add_u32 v22, s58, v42
    v_add_u32 v23, s58, v43
    ds_read_b128 a[0:3], v20 offset:0
    ds_read_b128 a[4:7], v21 offset:0
    ds_read_b128 a[8:11], v22 offset:0
    ds_read_b128 a[12:15], v23 offset:0
    ds_read_b128 a[16:19], v20 offset:256
    ds_read_b128 a[20:23], v21 offset:256
    ds_read_b128 a[24:27], v22 offset:256
    ds_read_b128 a[28:31], v23 offset:256
    s_add_u32 s11, s57, 8
    s_mov_b32 s6, 0
    s_cmp_eq_u32 s47, 1
    s_cselect_b32 s75, s66, 0
    s_mov_b32 s18, s75
    s_waitcnt lgkmcnt(0)
L_loop:
    s_cmp_lg_u32 s11, 24
    s_cbranch_scc1 L_wait_other
    s_waitcnt vmcnt(8)
L_waited:
    s_cmp_lg_u32 s18, 0
    s_cbranch_scc1 L_bar_special
    s_barrier
L_after_bar:
    ds_read_b128 v[96:99], v40 offset:0
    ds_read_b128 v[100:103], v40 offset:8192
    ds_read_b128 v[104:107], v41 offset:0
    ds_read_b128 v[108:111], v41 offset:8192
    ds_read_b128 v[112:115], v42 offset:0
    ds_read_b128 v[116:119], v42 offset:8192
    ds_read_b128 v[120:123], v43 offset:0
    ds_read_b128 v[124:127], v43 offset:8192
    ds_read_b128 v[128:131], v40 offset:256
    ds_read_b128 v[132:135], v40 offset:8448
    ds_read_b128 v[136:139], v41 offset:256
    ds_read_b128 v[140:143], v41 offset:8448
    s_cmp_lg_u32 s18, 0
    s_cbranch_scc1 L_post_special
L_more_load:
L_no_load:
    s_lshl_b32 s4, s4, 1
    s_cmp_ge_u32 s48, s5
    s_cbranch_scc1 L_claim
L_no_claim:
    s_cmp_eq_u32 s48, s7
    s_cbranch_scc1 L_sig
L_no_sig:
    s_cmp_eq_u32 s48, s67
    s_cbranch_scc1 L_poll
L_no_poll:
    s_cmp_eq_u32 s48, s3
    s_cbranch_scc1 L_step
L_step_ret:
    s_mov_b32 s98, -1
    s_cmp_ge_u32 s50, s47
    s_cbranch_scc1 L_ld_skip
    v_readlane_b32 s57, v2, s50
    v_readlane_b32 s58, v1, s50
    s_add_u32 s59, s51, s61
    s_mov_b32 m0, s59
    s_lshl_b32 s57, s57, 16
    s_and_b32 s58, s58, 63
    s_add_u32 s59, s59, 16384
    s_cmp_lt_u32 s58, 32
    s_cbranch_scc1 L_ldslow_7
    s_mov_b32 s98, s57
L_ldgo_8:
    s_add_u32 s50, s50, 1
    s_add_u32 s51, s51, 32768
    s_add_u32 s68, s68, 1
    s_cmp_eq_u32 s51, 98304
    s_cselect_b32 s51, 0, s51
L_ld_skip:
    v_readlane_b32 s56, v1, s48
    s_waitcnt lgkmcnt(10)
    v_mfma_f32_16x16x32_bf16 v[52:55], v[96:99], a[0:3], 0
    ds_read_b128 v[144:147], v42 offset:256
    v_mfma_f32_16x16x32_bf16 v[56:59], v[100:103], a[0:3], 0
    ds_read_b128 v[148:151], v42 offset:8448
    s_cmp_eq_u32 s98, -1
    s_cbranch_scc1 L_ldp_9
    buffer_load_dwordx4 v32, s[20:23], s98 offen offset:0 nt lds
L_ldp_9:
    s_waitcnt lgkmcnt(10)
    v_mfma_f32_16x16x32_bf16 v[52:55], v[104:107], a[4:7], v[52:55]
    ds_read_b128 v[152:155], v43 offset:256
    v_mfma_f32_16x16x32_bf16 v[56:59], v[108:111], a[4:7], v[56:59]
    ds_read_b128 v[156:159], v43 offset:8448
    s_waitcnt lgkmcnt(10)
    v_mfma_f32_16x16x32_bf16 v[52:55], v[112:115], a[8:11], v[52:55]
    ds_read_b64_tr_b16 v[160:161], v44 offset:0
    v_mfma_f32_16x16x32_bf16 v[56:59], v[116:119], a[8:11], v[56:59]
    ds_read_b64_tr_b16 v[162:163], v44 offset:8192
    s_cmp_eq_u32 s98, -1
    s_cbranch_scc1 L_ldp_10
    buffer_load_dwordx4 v33, s[20:23], s98 offen offset:1024 nt lds
L_ldp_10:
    s_waitcnt lgkmcnt(10)
    v_mfma_f32_16x16x32_bf16 v[52:55], v[120:123], a[12:15], v[52:55]
    ds_read_b64_tr_b16 v[164:165], v45 offset:0
    v_mfma_f32_16x16x32_bf16 v[56:59], v[124:127], a[12:15], v[56:59]
    ds_read_b64_tr_b16 v[166:167], v45 offset:8192
    s_waitcnt lgkmcnt(10)
    v_mfma_f32_16x16x32_bf16 v[52:55], v[128:131], a[16:19], v[52:55]
    ds_read_b64_tr_b16 v[168:169], v46 offset:0
    v_mfma_f32_16x16x32_bf16 v[56:59], v[132:135], a[16:19], v[56:59]
    ds_read_b64_tr_b16 v[170:171], v46 offset:8192
    ds_read_b64_tr_b16 v[172:173], v47 offset:0
    s_cmp_eq_u32 s98, -1
    s_cbranch_scc1 L_ldp_11
    buffer_load_dwordx4 v34, s[20:23], s98 offen offset:2048 nt lds
L_ldp_11:
    s_waitcnt lgkmcnt(11)
    v_mfma_f32_16x16x32_bf16 v[52:55], v[136:139], a[20:23], v[52:55]
    ds_read_b64_tr_b16 v[174:175], v47 offset:8192
    v_mfma_f32_16x16x32_bf16 v[56:59], v[140:143], a[20:23], v[56:59]
    ds_read_b64_tr_b16 v[176:177], v48 offset:0
    ds_read_b64_tr_b16 v[178:179], v48 offset:8192
    s_waitcnt lgkmcnt(12)
    v_mfma_f32_16x16x32_bf16 v[52:55], v[144:147], a[24:27], v[52:55]
    ds_read_b64_tr_b16 v[180:181], v49 offset:0
    v_mfma_f32_16x16x32_bf16 v[56:59], v[148:151], a[24:27], v[56:59]
    ds_read_b64_tr_b16 v[182:183], v49 offset:8192
    ds_read_b64_tr_b16 v[184:185], v50 offset:0
    s_cmp_eq_u32 s98, -1
    s_cbranch_scc1 L_ldp_12
    buffer_load_dwordx4 v35, s[20:23], s98 offen offset:3072 nt lds
    s_add_u32 m0, m0, 16384
L_ldp_12:
    s_waitcnt lgkmcnt(13)
    v_mfma_f32_16x16x32_bf16 v[52:55], v[152:155], a[28:31], v[52:55]
    ds_read_b64_tr_b16 v[186:187], v50 offset:8192
    v_mfma_f32_16x16x32_bf16 v[56:59], v[156:159], a[28:31], v[56:59]
    ds_read_b64_tr_b16 v[188:189], v51 offset:0
    ds_read_b64_tr_b16 v[190:191], v51 offset:8192
    s_add_u32 s49, s49, 32768
    s_cmp_eq_u32 s49, 98304
    s_cselect_b32 s49, 0, s49
    s_mov_b32 s74, 32768
    s_cmov_b32 s74, 0xffff0000
    s_bitcmp0_b32 s56, 5
    v_add_u32 v40, s74, v40
    v_add_u32 v41, s74, v41
    v_add_u32 v42, s74, v42
    v_add_u32 v43, s74, v43
    s_cbranch_scc1 L_mask
L_no_mask:
    v_max3_f32 v17, v52, v53, v54
    v_max3_f32 v17, v17, v55, v3
    v_max3_f32 v18, v56, v57, v58
    v_max3_f32 v3, v17, v18, v59
    s_cmp_eq_u32 s98, -1
    s_cbranch_scc1 L_ldp_13
    buffer_load_dwordx4 v36, s[24:27], s98 offen offset:0 nt lds
L_ldp_13:
    v_mov_b32 v16, v3
    v_add_u32 v44, s74, v44
    v_add_u32 v45, s74, v45
    v_permlane16_swap_b32 v3, v16
    v_add_u32 v46, s74, v46
    v_add_u32 v47, s74, v47
    v_max_f32 v3, v3, v16
    v_mov_b32 v16, v3
    v_add_u32 v48, s74, v48
    v_add_u32 v49, s74, v49
    v_permlane32_swap_b32 v3, v16
    v_add_u32 v50, s74, v50
    v_add_u32 v51, s74, v51
    v_max_f32 v3, v3, v16
    s_cmp_eq_u32 s98, -1
    s_cbranch_scc1 L_ldp_14
    buffer_load_dwordx4 v37, s[24:27], s98 offen offset:1024 nt lds
L_ldp_14:
    v_mul_f32 v17, s55, v3
    v_sub_f32 v24, v4, v17
    v_fma_f32 v52, v52, s55, -v17
    v_exp_f32 v24, v24
    v_fma_f32 v53, v53, s55, -v17
    v_fma_f32 v54, v54, s55, -v17
    v_fma_f32 v55, v55, s55, -v17
    v_fma_f32 v56, v56, s55, -v17
    v_fma_f32 v57, v57, s55, -v17
    v_fma_f32 v58, v58, s55, -v17
    v_fma_f32 v59, v59, s55, -v17
    s_cmp_eq_u32 s98, -1
    s_cbranch_scc1 L_ldp_15
    buffer_load_dwordx4 v38, s[24:27], s98 offen offset:2048 nt lds
L_ldp_15:
    v_mov_b32 v4, v17
    v_cmp_neq_f32 vcc, 1.0, v24
    v_exp_f32 v52, v52
    v_exp_f32 v53, v53
    v_exp_f32 v54, v54
    v_exp_f32 v55, v55
    v_cvt_pk_bf16_f32 v60, v52, v53
    s_cmp_eq_u32 s98, -1
    s_cbranch_scc1 L_ldp_16
    buffer_load_dwordx4 v39, s[24:27], s98 offen offset:3072 nt lds
L_ldp_16:
    v_exp_f32 v56, v56
    v_exp_f32 v57, v57
    v_cvt_pk_bf16_f32 v61, v54, v55
    v_exp_f32 v58, v58
    v_exp_f32 v59, v59
    v_cvt_pk_bf16_f32 v62, v56, v57
    s_waitcnt lgkmcnt(0)
    v_cvt_pk_bf16_f32 v63, v58, v59
    s_cbranch_vccnz L_pv_scale
    v_add_f32 v17, v52, v53
    s_sub_u32 s57, s50, s48
    v_mfma_f32_16x16x32_bf16 v[64:67], v[160:163], v[60:63], v[64:67]
    s_lshl3_add_u32 s57, s57, s6
    v_mfma_f32_16x16x32_bf16 v[68:71], v[164:167], v[60:63], v[68:71]
    v_add_f32 v18, v54, v55
    s_add_u32 s11, s57, s101
    v_mfma_f32_16x16x32_bf16 v[72:75], v[168:171], v[60:63], v[72:75]
    v_add_f32 v19, v56, v57
    s_mov_b32 s6, 0
    v_mfma_f32_16x16x32_bf16 v[76:79], v[172:175], v[60:63], v[76:79]
    v_add_f32 v20, v58, v59
    s_mov_b32 s101, 0
    v_mfma_f32_16x16x32_bf16 v[80:83], v[176:179], v[60:63], v[80:83]
    v_add_f32 v17, v17, v18
    s_add_u32 s57, s48, 2
    s_cmp_eq_u32 s57, s47
    v_mfma_f32_16x16x32_bf16 v[84:87], v[180:183], v[60:63], v[84:87]
    v_add_f32 v19, v19, v20
    s_cselect_b32 s75, s66, 0
    s_and_b32 s18, s4, 2
    v_mfma_f32_16x16x32_bf16 v[88:91], v[184:187], v[60:63], v[88:91]
    v_add_f32 v17, v17, v19
    s_or_b32 s18, s18, s75
    s_add_u32 s48, s48, 1
    v_mfma_f32_16x16x32_bf16 v[92:95], v[188:191], v[60:63], v[92:95]
    v_fma_f32 v5, v5, v24, v17
    s_sub_u32 s57, s48, 1
    s_bitcmp0_b64 s[62:63], s57
    s_cbranch_scc1 L_loop
L_piece_end:
    s_sub_u32 s48, s48, 1
    s_nop 3
    v_mov_b32 v16, v5
    s_nop 1
    v_permlane16_swap_b32 v5, v16
    s_nop 1
    v_add_f32 v5, v5, v16
    v_mov_b32 v16, v5
    s_nop 1
    v_permlane32_swap_b32 v5, v16
    s_nop 1
    v_add_f32 v5, v5, v16
    s_cmp_lg_u32 s64, 0
    s_cbranch_scc1 L_owner_end
    s_bitset1_b64 s[8:9], s48
    s_add_u32 s7, s48, 3
    s_max_u32 s7, s7, 12
    s_add_u32 s48, s48, 1
    s_cmp_ge_u32 s48, s47
    s_cbranch_scc1 L_helper_end
    s_cmp_ge_u32 s68, 3
    s_cbranch_scc1 L_qn_in
    s_cmp_lt_u32 s68, 2
    s_cbranch_scc1 L_wn_18
    s_waitcnt vmcnt(16)
    s_branch L_wend_17
L_wn_18:
    s_cmp_lt_u32 s68, 1
    s_cbranch_scc1 L_wn_19
    s_waitcnt vmcnt(8)
    s_branch L_wend_17
L_wn_19:
    s_waitcnt vmcnt(0)
L_wend_17:
    s_barrier
L_qn_in:
    s_sub_u32 s58, s10, s49
    s_xor_b32 s10, s10, 16384
    s_and_b32 s60, s72, 0x2000
    s_add_u32 s58, s58, s60
    v_add_u32 v20, s58, v40
    v_add_u32 v21, s58, v41
    v_add_u32 v22, s58, v42
    v_add_u32 v23, s58, v43
    ds_read_b128 a[0:3], v20 offset:0
    ds_read_b128 a[4:7], v21 offset:0
    ds_read_b128 a[8:11], v22 offset:0
    ds_read_b128 a[12:15], v23 offset:0
    ds_read_b128 a[16:19], v20 offset:256
    ds_read_b128 a[20:23], v21 offset:256
    ds_read_b128 a[24:27], v22 offset:256
    ds_read_b128 a[28:31], v23 offset:256
    v_rcp_f32 v24, v5
    v_log_f32 v18, v5
    s_lshl_b32 s59, s69, 4
    s_sub_u32 s59, s59, 210
    s_add_u32 s60, s69, s54
    s_cmp_lt_u32 s69, 16
    s_cselect_b32 s59, s60, s59
    s_add_u32 s59, s59, s54
    s_mul_i32 s59, s59, 17408
    s_add_u32 s59, s59, s73
    v_add_f32 v18, v18, v4
    s_add_u32 s60, s59, 4096
    buffer_store_dword v18, v15, s[40:43], s60 offen sc1
    v_pk_mul_f32 v[240:241], v[64:65], v[24:25] op_sel_hi:[1,0]
    v_cvt_pk_bf16_f32 v96, v240, v241
    v_pk_mul_f32 v[242:243], v[66:67], v[24:25] op_sel_hi:[1,0]
    v_cvt_pk_bf16_f32 v97, v242, v243
    v_pk_mul_f32 v[240:241], v[68:69], v[24:25] op_sel_hi:[1,0]
    v_cvt_pk_bf16_f32 v98, v240, v241
    v_pk_mul_f32 v[242:243], v[70:71], v[24:25] op_sel_hi:[1,0]
    v_cvt_pk_bf16_f32 v99, v242, v243
    buffer_store_dwordx4 v[96:99], v13, s[40:43], s59 offen offset:0 sc1
    v_pk_mul_f32 v[240:241], v[72:73], v[24:25] op_sel_hi:[1,0]
    v_cvt_pk_bf16_f32 v100, v240, v241
    v_pk_mul_f32 v[242:243], v[74:75], v[24:25] op_sel_hi:[1,0]
    v_cvt_pk_bf16_f32 v101, v242, v243
    v_pk_mul_f32 v[240:241], v[76:77], v[24:25] op_sel_hi:[1,0]
    v_cvt_pk_bf16_f32 v102, v240, v241
    v_pk_mul_f32 v[242:243], v[78:79], v[24:25] op_sel_hi:[1,0]
    v_cvt_pk_bf16_f32 v103, v242, v243
    buffer_store_dwordx4 v[100:103], v13, s[40:43], s59 offen offset:1024 sc1
    v_pk_mul_f32 v[240:241], v[80:81], v[24:25] op_sel_hi:[1,0]
    v_cvt_pk_bf16_f32 v104, v240, v241
    v_pk_mul_f32 v[242:243], v[82:83], v[24:25] op_sel_hi:[1,0]
    v_cvt_pk_bf16_f32 v105, v242, v243
    v_pk_mul_f32 v[240:241], v[84:85], v[24:25] op_sel_hi:[1,0]
    v_cvt_pk_bf16_f32 v106, v240, v241
    v_pk_mul_f32 v[242:243], v[86:87], v[24:25] op_sel_hi:[1,0]
    v_cvt_pk_bf16_f32 v107, v242, v243
    buffer_store_dwordx4 v[104:107], v13, s[40:43], s59 offen offset:2048 sc1
    v_pk_mul_f32 v[240:241], v[88:89], v[24:25] op_sel_hi:[1,0]
    v_cvt_pk_bf16_f32 v108, v240, v241
    v_pk_mul_f32 v[242:243], v[90:91], v[24:25] op_sel_hi:[1,0]
    v_cvt_pk_bf16_f32 v109, v242, v243
    v_pk_mul_f32 v[240:241], v[92:93], v[24:25] op_sel_hi:[1,0]
    v_cvt_pk_bf16_f32 v110, v240, v241
    v_pk_mul_f32 v[242:243], v[94:95], v[24:25] op_sel_hi:[1,0]
    v_cvt_pk_bf16_f32 v111, v242, v243
    buffer_store_dwordx4 v[108:111], v13, s[40:43], s59 offen offset:3072 sc1
    s_nop 1
    s_mov_b32 s101, 5
    s_add_u32 s11, s11, 5
    s_waitcnt lgkmcnt(0)
    v_mov_b32 v64, 0
    v_mov_b32 v65, 0
    v_mov_b32 v66, 0
    v_mov_b32 v67, 0
    v_mov_b32 v68, 0
    v_mov_b32 v69, 0
    v_mov_b32 v70, 0
    v_mov_b32 v71, 0
    v_mov_b32 v72, 0
    v_mov_b32 v73, 0
    v_mov_b32 v74, 0
    v_mov_b32 v75, 0
    v_mov_b32 v76, 0
    v_mov_b32 v77, 0
    v_mov_b32 v78, 0
    v_mov_b32 v79, 0
    v_mov_b32 v80, 0
    v_mov_b32 v81, 0
    v_mov_b32 v82, 0
    v_mov_b32 v83, 0
    v_mov_b32 v84, 0
    v_mov_b32 v85, 0
    v_mov_b32 v86, 0
    v_mov_b32 v87, 0
    v_mov_b32 v88, 0
    v_mov_b32 v89, 0
    v_mov_b32 v90, 0
    v_mov_b32 v91, 0
    v_mov_b32 v92, 0
    v_mov_b32 v93, 0
    v_mov_b32 v94, 0
    v_mov_b32 v95, 0
    v_mov_b32 v3, 0xff61b1e6
    v_mov_b32 v5, 0
    v_readlane_b32 s56, v1, s48
    s_bfe_u32 s54, s56, 0x40008
    s_bitcmp1_b32 s56, 13
    s_cselect_b32 s55, 0, 0x3db8aa3b
    v_mul_f32 v4, s55, v3
    s_lshr_b64 s[78:79], s[62:63], s48
    s_cbranch_scc0 L_loop
    s_ff1_i32_b64 s57, s[78:79]
    s_add_u32 s57, s57, s48
    s_add_u32 s57, s57, 1
    s_cmp_ge_u32 s57, s47
    s_cbranch_scc1 L_loop
    v_readlane_b32 s58, v1, s57
    s_bfe_u32 s58, s58, 0x40008
    s_add_u32 m0, s61, s10
    s_lshl_b32 s60, s58, 17
    v_xor_b32 v243, 32, v8
    v_xor_b32 v244, 64, v8
    v_xor_b32 v245, 96, v8
    buffer_load_dwordx4 v8, s[28:31], s60 offen offset:0 lds
    buffer_load_dwordx4 v243, s[28:31], s60 offen offset:1024 lds
    buffer_load_dwordx4 v244, s[28:31], s60 offen offset:2048 lds
    buffer_load_dwordx4 v245, s[28:31], s60 offen offset:3072 lds
    s_mov_b32 s101, 9
    s_add_u32 s11, s11, 4
    s_mov_b32 s68, 0
    s_branch L_loop
L_helper_end:
    s_bitcmp1_b32 s14, s69
    s_cselect_b32 s75, 17, s69
    v_rcp_f32 v24, v5
    v_log_f32 v18, v5
    s_lshl_b32 s59, s75, 4
    s_sub_u32 s59, s59, 210
    s_add_u32 s60, s75, s54
    s_cmp_lt_u32 s75, 16
    s_cselect_b32 s59, s60, s59
    s_add_u32 s59, s59, s54
    s_mul_i32 s59, s59, 17408
    s_add_u32 s59, s59, s73
    v_add_f32 v18, v18, v4
    s_add_u32 s60, s59, 4096
    buffer_store_dword v18, v15, s[40:43], s60 offen sc1
    v_pk_mul_f32 v[240:241], v[64:65], v[24:25] op_sel_hi:[1,0]
    v_cvt_pk_bf16_f32 v96, v240, v241
    v_pk_mul_f32 v[242:243], v[66:67], v[24:25] op_sel_hi:[1,0]
    v_cvt_pk_bf16_f32 v97, v242, v243
    v_pk_mul_f32 v[240:241], v[68:69], v[24:25] op_sel_hi:[1,0]
    v_cvt_pk_bf16_f32 v98, v240, v241
    v_pk_mul_f32 v[242:243], v[70:71], v[24:25] op_sel_hi:[1,0]
    v_cvt_pk_bf16_f32 v99, v242, v243
    buffer_store_dwordx4 v[96:99], v13, s[40:43], s59 offen offset:0 sc1
    v_pk_mul_f32 v[240:241], v[72:73], v[24:25] op_sel_hi:[1,0]
    v_cvt_pk_bf16_f32 v100, v240, v241
    v_pk_mul_f32 v[242:243], v[74:75], v[24:25] op_sel_hi:[1,0]
    v_cvt_pk_bf16_f32 v101, v242, v243
    v_pk_mul_f32 v[240:241], v[76:77], v[24:25] op_sel_hi:[1,0]
    v_cvt_pk_bf16_f32 v102, v240, v241
    v_pk_mul_f32 v[242:243], v[78:79], v[24:25] op_sel_hi:[1,0]
    v_cvt_pk_bf16_f32 v103, v242, v243
    buffer_store_dwordx4 v[100:103], v13, s[40:43], s59 offen offset:1024 sc1
    v_pk_mul_f32 v[240:241], v[80:81], v[24:25] op_sel_hi:[1,0]
    v_cvt_pk_bf16_f32 v104, v240, v241
    v_pk_mul_f32 v[242:243], v[82:83], v[24:25] op_sel_hi:[1,0]
    v_cvt_pk_bf16_f32 v105, v242, v243
    v_pk_mul_f32 v[240:241], v[84:85], v[24:25] op_sel_hi:[1,0]
    v_cvt_pk_bf16_f32 v106, v240, v241
    v_pk_mul_f32 v[242:243], v[86:87], v[24:25] op_sel_hi:[1,0]
    v_cvt_pk_bf16_f32 v107, v242, v243
    buffer_store_dwordx4 v[104:107], v13, s[40:43], s59 offen offset:2048 sc1
    v_pk_mul_f32 v[240:241], v[88:89], v[24:25] op_sel_hi:[1,0]
    v_cvt_pk_bf16_f32 v108, v240, v241
    v_pk_mul_f32 v[242:243], v[90:91], v[24:25] op_sel_hi:[1,0]
    v_cvt_pk_bf16_f32 v109, v242, v243
    v_pk_mul_f32 v[240:241], v[92:93], v[24:25] op_sel_hi:[1,0]
    v_cvt_pk_bf16_f32 v110, v240, v241
    v_pk_mul_f32 v[242:243], v[94:95], v[24:25] op_sel_hi:[1,0]
    v_cvt_pk_bf16_f32 v111, v242, v243
    buffer_store_dwordx4 v[108:111], v13, s[40:43], s59 offen offset:3072 sc1
    s_nop 1
L_bsy_20:
    s_waitcnt vmcnt(0)
    s_cmp_ge_u32 s19, 3
    s_cbranch_scc1 L_bsd_21
    s_add_u32 s19, s19, 1
    s_add_u32 s3, s3, 2
    s_cmp_eq_u32 s19, 3
    s_cselect_b32 s3, -1, s3
    s_cmp_lg_u32 s44, 0
    s_cbranch_scc1 L_bsy_20
    s_cmp_eq_u32 s19, 3
    s_cbranch_scc1 L_bs2_23
    s_add_u32 s6, s6, 1
    v_mov_b32 v196, 0
    s_mov_b64 exec, s[0:1]
    buffer_atomic_or v196, v197, s[36:39], 0 offen sc0
    s_mov_b64 exec, -1
    s_branch L_bsy_20
L_bs2_23:
    v_bfe_u32 v196, v196, v200, 16
    v_cmp_gt_u32 vcc, 0x8000, v196
    s_nop 1
    v_cndmask_b32 v198, v196, v195, vcc
    v_and_b32 v198, 0x7fff, v198
    v_or_b32 v199, 0x8000, v198
    v_readlane_b32 s77, v198, 63
    v_lshlrev_b32 v199, v200, v199
    s_not_b64 exec, s[0:1]
    s_nop 0
    v_mov_b32 v198, s77
    s_mov_b64 exec, -1
    s_and_b64 s[78:79], vcc, s[0:1]
    s_cbranch_scc0 L_bsy_20
    s_add_u32 s6, s6, 1
    s_mov_b64 exec, s[78:79]
    buffer_atomic_or v199, v197, s[36:39], 0 offen sc0
    s_mov_b64 exec, -1
    s_branch L_bsy_20
L_bsd_21:
    s_andn2_b64 s[78:79], s[62:63], s[16:17]
    s_barrier
    s_cmp_lg_u32 s44, 0
    s_cbranch_scc1 L_h_sig_done
    s_mov_b64 exec, s[78:79]
    buffer_atomic_add v194, v193, s[40:43], 0 offen sc0
    s_mov_b64 exec, -1
    s_waitcnt vmcnt(0)
    v_sub_u32 v21, v194, v198
    v_and_b32 v21, 0xff, v21
    ds_write_b32 v15, v21
    s_waitcnt lgkmcnt(0)
L_h_sig_done:
    s_barrier
    ds_read_b32 v12, v15
    s_waitcnt lgkmcnt(0)
L_h_check:
    s_cmp_eq_u64 s[62:63], 0
    s_cbranch_scc1 L_fin
    s_ff1_i32_b64 s48, s[62:63]
    s_bitset0_b64 s[62:63], s48
    v_readlane_b32 s56, v1, s48
    v_readlane_b32 s75, v12, s48
    s_bfe_u32 s54, s56, 0x40008
    v_readlane_b32 s57, v9, s54
    v_readlane_b32 s58, v10, s54
    s_lshr_b32 s59, s14, s54
    s_sub_u32 s58, s57, s58
    v_max_u32 v16, s58, v31
    v_min_u32 v17, s57, v255
    v_cmp_lt_u32 vcc, v16, v17
    s_and_b32 s59, s59, 1
    s_lshl_b32 s59, s59, 17
    s_nop 1
    s_and_b32 s65, vcc_lo, 0xffff
    s_or_b32 s65, s65, s59
    s_bcnt1_i32_b32 s66, s65
    s_cmp_lg_u32 s75, s66
    s_cbranch_scc1 L_h_check
    v_mov_b32 v64, 0
    v_mov_b32 v65, 0
    v_mov_b32 v66, 0
    v_mov_b32 v67, 0
    v_mov_b32 v68, 0
    v_mov_b32 v69, 0
    v_mov_b32 v70, 0
    v_mov_b32 v71, 0
    v_mov_b32 v72, 0
    v_mov_b32 v73, 0
    v_mov_b32 v74, 0
    v_mov_b32 v75, 0
    v_mov_b32 v76, 0
    v_mov_b32 v77, 0
    v_mov_b32 v78, 0
    v_mov_b32 v79, 0
    v_mov_b32 v80, 0
    v_mov_b32 v81, 0
    v_mov_b32 v82, 0
    v_mov_b32 v83, 0
    v_mov_b32 v84, 0
    v_mov_b32 v85, 0
    v_mov_b32 v86, 0
    v_mov_b32 v87, 0
    v_mov_b32 v88, 0
    v_mov_b32 v89, 0
    v_mov_b32 v90, 0
    v_mov_b32 v91, 0
    v_mov_b32 v92, 0
    v_mov_b32 v93, 0
    v_mov_b32 v94, 0
    v_mov_b32 v95, 0
    v_mov_b32 v3, 0xff61b1e6
    v_mov_b32 v5, 0
    v_mov_b32 v4, 0xff61b1e6
    s_bitset1_b32 s65, 16
    s_branch L_combine
L_owner_end:
    s_mov_b64 s[62:63], 0
    s_cmp_eq_u32 s66, 0
    s_cbranch_scc1 L_output
    s_cmp_lg_u32 s71, 0
    s_cbranch_scc1 L_merge
L_bsy_25:
    s_waitcnt vmcnt(0)
    s_cmp_ge_u32 s19, 3
    s_cbranch_scc1 L_bsd_26
    s_add_u32 s19, s19, 1
    s_add_u32 s3, s3, 2
    s_cmp_eq_u32 s19, 3
    s_cselect_b32 s3, -1, s3
    s_cmp_lg_u32 s44, 0
    s_cbranch_scc1 L_bsy_25
    s_cmp_eq_u32 s19, 3
    s_cbranch_scc1 L_bs2_28
    s_add_u32 s6, s6, 1
    v_mov_b32 v196, 0
    s_mov_b64 exec, s[0:1]
    buffer_atomic_or v196, v197, s[36:39], 0 offen sc0
    s_mov_b64 exec, -1
    s_branch L_bsy_25
L_bs2_28:
    v_bfe_u32 v196, v196, v200, 16
    v_cmp_gt_u32 vcc, 0x8000, v196
    s_nop 1
    v_cndmask_b32 v198, v196, v195, vcc
    v_and_b32 v198, 0x7fff, v198
    v_or_b32 v199, 0x8000, v198
    v_readlane_b32 s77, v198, 63
    v_lshlrev_b32 v199, v200, v199
    s_not_b64 exec, s[0:1]
    s_nop 0
    v_mov_b32 v198, s77
    s_mov_b64 exec, -1
    s_and_b64 s[78:79], vcc, s[0:1]
    s_cbranch_scc0 L_bsy_25
    s_add_u32 s6, s6, 1
    s_mov_b64 exec, s[78:79]
    buffer_atomic_or v199, v197, s[36:39], 0 offen sc0
    s_mov_b64 exec, -1
    s_branch L_bsy_25
L_bsd_26:
    s_mov_b32 s75, 6
L_spin:
    s_cmp_lg_u32 s44, 0
    s_cbranch_scc1 L_spin_bar
    s_cmp_eq_u32 s67, s48
    s_mov_b32 s67, -1
    s_cbranch_scc1 L_spin_have
    buffer_load_dword v12, off, s[40:43], s76 sc1
L_spin_have:
    s_waitcnt vmcnt(0)
    v_subrev_u32 v12, s77, v12
    ds_write_b32 v251, v12 offset:8
    s_waitcnt lgkmcnt(0)
L_spin_bar:
    s_barrier
    ds_read_b32 v12, v251 offset:8
    s_waitcnt lgkmcnt(0)
    v_readfirstlane_b32 s57, v12
    s_barrier
    s_and_b32 s57, s57, 0xff
    s_cmp_eq_u32 s57, s66
    s_cbranch_scc1 L_combine
    s_sub_u32 s75, s75, 1
    s_cmp_lg_u32 s75, 0
    s_cbranch_scc1 L_spin
    s_mov_b32 s75, 16
    v_rcp_f32 v24, v5
    v_log_f32 v18, v5
    s_lshl_b32 s59, s75, 4
    s_sub_u32 s59, s59, 210
    s_add_u32 s60, s75, s54
    s_cmp_lt_u32 s75, 16
    s_cselect_b32 s59, s60, s59
    s_add_u32 s59, s59, s54
    s_mul_i32 s59, s59, 17408
    s_add_u32 s59, s59, s73
    v_add_f32 v18, v18, v4
    s_add_u32 s60, s59, 4096
    buffer_store_dword v18, v15, s[40:43], s60 offen sc1
    v_pk_mul_f32 v[240:241], v[64:65], v[24:25] op_sel_hi:[1,0]
    v_cvt_pk_bf16_f32 v96, v240, v241
    v_pk_mul_f32 v[242:243], v[66:67], v[24:25] op_sel_hi:[1,0]
    v_cvt_pk_bf16_f32 v97, v242, v243
    v_pk_mul_f32 v[240:241], v[68:69], v[24:25] op_sel_hi:[1,0]
    v_cvt_pk_bf16_f32 v98, v240, v241
    v_pk_mul_f32 v[242:243], v[70:71], v[24:25] op_sel_hi:[1,0]
    v_cvt_pk_bf16_f32 v99, v242, v243
    buffer_store_dwordx4 v[96:99], v13, s[40:43], s59 offen offset:0 sc1
    v_pk_mul_f32 v[240:241], v[72:73], v[24:25] op_sel_hi:[1,0]
    v_cvt_pk_bf16_f32 v100, v240, v241
    v_pk_mul_f32 v[242:243], v[74:75], v[24:25] op_sel_hi:[1,0]
    v_cvt_pk_bf16_f32 v101, v242, v243
    v_pk_mul_f32 v[240:241], v[76:77], v[24:25] op_sel_hi:[1,0]
    v_cvt_pk_bf16_f32 v102, v240, v241
    v_pk_mul_f32 v[242:243], v[78:79], v[24:25] op_sel_hi:[1,0]
    v_cvt_pk_bf16_f32 v103, v242, v243
    buffer_store_dwordx4 v[100:103], v13, s[40:43], s59 offen offset:1024 sc1
    v_pk_mul_f32 v[240:241], v[80:81], v[24:25] op_sel_hi:[1,0]
    v_cvt_pk_bf16_f32 v104, v240, v241
    v_pk_mul_f32 v[242:243], v[82:83], v[24:25] op_sel_hi:[1,0]
    v_cvt_pk_bf16_f32 v105, v242, v243
    v_pk_mul_f32 v[240:241], v[84:85], v[24:25] op_sel_hi:[1,0]
    v_cvt_pk_bf16_f32 v106, v240, v241
    v_pk_mul_f32 v[242:243], v[86:87], v[24:25] op_sel_hi:[1,0]
    v_cvt_pk_bf16_f32 v107, v242, v243
    buffer_store_dwordx4 v[104:107], v13, s[40:43], s59 offen offset:2048 sc1
    v_pk_mul_f32 v[240:241], v[88:89], v[24:25] op_sel_hi:[1,0]
    v_cvt_pk_bf16_f32 v108, v240, v241
    v_pk_mul_f32 v[242:243], v[90:91], v[24:25] op_sel_hi:[1,0]
    v_cvt_pk_bf16_f32 v109, v242, v243
    v_pk_mul_f32 v[240:241], v[92:93], v[24:25] op_sel_hi:[1,0]
    v_cvt_pk_bf16_f32 v110, v240, v241
    v_pk_mul_f32 v[242:243], v[94:95], v[24:25] op_sel_hi:[1,0]
    v_cvt_pk_bf16_f32 v111, v242, v243
    buffer_store_dwordx4 v[108:111], v13, s[40:43], s59 offen offset:3072 sc1
    s_nop 1
    v_mov_b32 v21, 1
    s_waitcnt vmcnt(0)
    s_barrier
    s_cmp_lg_u32 s44, 0
    s_cbranch_scc1 L_o_sig_done
    s_mov_b64 s[82:83], exec
    s_mov_b64 exec, 1
    buffer_atomic_add v21, off, s[40:43], s76 sc0
    s_mov_b64 exec, s[82:83]
    s_waitcnt vmcnt(0)
    v_subrev_u32 v21, s77, v21
    ds_write_b32 v15, v21
    s_waitcnt lgkmcnt(0)
L_o_sig_done:
    s_barrier
    ds_read_b32 v12, v15
    s_waitcnt lgkmcnt(0)
    v_readfirstlane_b32 s57, v12
    s_and_b32 s57, s57, 0xff
    s_cmp_lg_u32 s57, s66
    s_cbranch_scc1 L_fin
L_combine:
    s_mov_b32 s70, 0
    s_cmp_eq_u32 s65, 0
    s_cbranch_scc1 L_i3done_30
    s_ff1_i32_b32 s57, s65
    s_bitset0_b32 s65, s57
    s_lshl_b32 s59, s57, 4
    s_sub_u32 s59, s59, 210
    s_add_u32 s60, s57, s54
    s_cmp_lt_u32 s57, 16
    s_cselect_b32 s59, s60, s59
    s_add_u32 s59, s59, s54
    s_mul_i32 s59, s59, 17408
    s_add_u32 s59, s59, s73
    buffer_load_dwordx4 v[192:195], v13, s[40:43], s59 offen offset:0 sc1
    buffer_load_dwordx4 v[196:199], v13, s[40:43], s59 offen offset:1024 sc1
    buffer_load_dwordx4 v[200:203], v13, s[40:43], s59 offen offset:2048 sc1
    buffer_load_dwordx4 v[204:207], v13, s[40:43], s59 offen offset:3072 sc1
    s_add_u32 s59, s59, 4096
    buffer_load_dword v28, v15, s[40:43], s59 offen sc1
    s_mov_b32 s70, 1
    s_cmp_eq_u32 s65, 0
    s_cbranch_scc1 L_i3done_30
    s_ff1_i32_b32 s57, s65
    s_bitset0_b32 s65, s57
    s_lshl_b32 s59, s57, 4
    s_sub_u32 s59, s59, 210
    s_add_u32 s60, s57, s54
    s_cmp_lt_u32 s57, 16
    s_cselect_b32 s59, s60, s59
    s_add_u32 s59, s59, s54
    s_mul_i32 s59, s59, 17408
    s_add_u32 s59, s59, s73
    buffer_load_dwordx4 v[208:211], v13, s[40:43], s59 offen offset:0 sc1
    buffer_load_dwordx4 v[212:215], v13, s[40:43], s59 offen offset:1024 sc1
    buffer_load_dwordx4 v[216:219], v13, s[40:43], s59 offen offset:2048 sc1
    buffer_load_dwordx4 v[220:223], v13, s[40:43], s59 offen offset:3072 sc1
    s_add_u32 s59, s59, 4096
    buffer_load_dword v29, v15, s[40:43], s59 offen sc1
    s_mov_b32 s70, 2
    s_cmp_eq_u32 s65, 0
    s_cbranch_scc1 L_i3done_30
    s_ff1_i32_b32 s57, s65
    s_bitset0_b32 s65, s57
    s_lshl_b32 s59, s57, 4
    s_sub_u32 s59, s59, 210
    s_add_u32 s60, s57, s54
    s_cmp_lt_u32 s57, 16
    s_cselect_b32 s59, s60, s59
    s_add_u32 s59, s59, s54
    s_mul_i32 s59, s59, 17408
    s_add_u32 s59, s59, s73
    buffer_load_dwordx4 v[224:227], v13, s[40:43], s59 offen offset:0 sc1
    buffer_load_dwordx4 v[228:231], v13, s[40:43], s59 offen offset:1024 sc1
    buffer_load_dwordx4 v[232:235], v13, s[40:43], s59 offen offset:2048 sc1
    buffer_load_dwordx4 v[236:239], v13, s[40:43], s59 offen offset:3072 sc1
    s_add_u32 s59, s59, 4096
    buffer_load_dword v30, v15, s[40:43], s59 offen sc1
    s_mov_b32 s70, 3
L_i3done_30:
L_merge:
    s_lshl_b32 s60, s54, 17
    s_add_u32 s60, s60, s72
    s_cmp_gt_u32 s70, 2
    s_cbranch_scc1 L_merge_many
    s_cmp_eq_u32 s70, 2
    s_cbranch_scc1 L_merge_two
    v_mov_b32 v29, 0xff61b1e6
L_merge_two:
    s_waitcnt vmcnt(0)
    v_max3_f32 v16, v4, v28, v29
    v_sub_f32 v24, v4, v16
    v_sub_f32 v26, v28, v16
    v_sub_f32 v20, v29, v16
    v_exp_f32 v24, v24
    v_exp_f32 v26, v26
    v_exp_f32 v20, v20
    v_fma_f32 v5, v5, v24, v26
    v_add_f32 v5, v5, v20
    v_rcp_f32 v5, v5
    s_cmp_lg_u32 s70, 2
    v_mul_f32 v24, v24, v5
    v_mul_f32 v26, v26, v5
    v_mul_f32 v20, v20, v5
    v_lshlrev_b32 v240, 16, v192
    v_and_b32 v241, 0xffff0000, v192
    v_pk_mul_f32 v[64:65], v[64:65], v[24:25] op_sel_hi:[1,0]
    v_pk_fma_f32 v[64:65], v[240:241], v[26:27], v[64:65] op_sel_hi:[1,0,1]
    v_lshlrev_b32 v242, 16, v193
    v_and_b32 v243, 0xffff0000, v193
    v_pk_mul_f32 v[66:67], v[66:67], v[24:25] op_sel_hi:[1,0]
    v_pk_fma_f32 v[66:67], v[242:243], v[26:27], v[66:67] op_sel_hi:[1,0,1]
    v_lshlrev_b32 v240, 16, v194
    v_and_b32 v241, 0xffff0000, v194
    v_pk_mul_f32 v[68:69], v[68:69], v[24:25] op_sel_hi:[1,0]
    v_pk_fma_f32 v[68:69], v[240:241], v[26:27], v[68:69] op_sel_hi:[1,0,1]
    v_lshlrev_b32 v242, 16, v195
    v_and_b32 v243, 0xffff0000, v195
    v_pk_mul_f32 v[70:71], v[70:71], v[24:25] op_sel_hi:[1,0]
    v_pk_fma_f32 v[70:71], v[242:243], v[26:27], v[70:71] op_sel_hi:[1,0,1]
    s_cbranch_scc1 L_mone_31
    v_lshlrev_b32 v240, 16, v208
    v_and_b32 v241, 0xffff0000, v208
    v_pk_fma_f32 v[64:65], v[240:241], v[20:21], v[64:65] op_sel_hi:[1,0,1]
    v_lshlrev_b32 v242, 16, v209
    v_and_b32 v243, 0xffff0000, v209
    v_pk_fma_f32 v[66:67], v[242:243], v[20:21], v[66:67] op_sel_hi:[1,0,1]
    v_lshlrev_b32 v240, 16, v210
    v_and_b32 v241, 0xffff0000, v210
    v_pk_fma_f32 v[68:69], v[240:241], v[20:21], v[68:69] op_sel_hi:[1,0,1]
    v_lshlrev_b32 v242, 16, v211
    v_and_b32 v243, 0xffff0000, v211
    v_pk_fma_f32 v[70:71], v[242:243], v[20:21], v[70:71] op_sel_hi:[1,0,1]
L_mone_31:
    v_cvt_pk_bf16_f32 v96, v64, v65
    v_cvt_pk_bf16_f32 v98, v68, v69
    v_cvt_pk_bf16_f32 v97, v66, v67
    v_cvt_pk_bf16_f32 v99, v70, v71
    s_nop 0
    v_permlane16_swap_b32 v96, v98
    v_permlane16_swap_b32 v97, v99
    buffer_store_dwordx4 v[96:99], v14, s[32:35], s60 offen offset:0 nt
    v_lshlrev_b32 v240, 16, v196
    v_and_b32 v241, 0xffff0000, v196
    v_pk_mul_f32 v[72:73], v[72:73], v[24:25] op_sel_hi:[1,0]
    v_pk_fma_f32 v[72:73], v[240:241], v[26:27], v[72:73] op_sel_hi:[1,0,1]
    v_lshlrev_b32 v242, 16, v197
    v_and_b32 v243, 0xffff0000, v197
    v_pk_mul_f32 v[74:75], v[74:75], v[24:25] op_sel_hi:[1,0]
    v_pk_fma_f32 v[74:75], v[242:243], v[26:27], v[74:75] op_sel_hi:[1,0,1]
    v_lshlrev_b32 v240, 16, v198
    v_and_b32 v241, 0xffff0000, v198
    v_pk_mul_f32 v[76:77], v[76:77], v[24:25] op_sel_hi:[1,0]
    v_pk_fma_f32 v[76:77], v[240:241], v[26:27], v[76:77] op_sel_hi:[1,0,1]
    v_lshlrev_b32 v242, 16, v199
    v_and_b32 v243, 0xffff0000, v199
    v_pk_mul_f32 v[78:79], v[78:79], v[24:25] op_sel_hi:[1,0]
    v_pk_fma_f32 v[78:79], v[242:243], v[26:27], v[78:79] op_sel_hi:[1,0,1]
    s_cbranch_scc1 L_mone_32
    v_lshlrev_b32 v240, 16, v212
    v_and_b32 v241, 0xffff0000, v212
    v_pk_fma_f32 v[72:73], v[240:241], v[20:21], v[72:73] op_sel_hi:[1,0,1]
    v_lshlrev_b32 v242, 16, v213
    v_and_b32 v243, 0xffff0000, v213
    v_pk_fma_f32 v[74:75], v[242:243], v[20:21], v[74:75] op_sel_hi:[1,0,1]
    v_lshlrev_b32 v240, 16, v214
    v_and_b32 v241, 0xffff0000, v214
    v_pk_fma_f32 v[76:77], v[240:241], v[20:21], v[76:77] op_sel_hi:[1,0,1]
    v_lshlrev_b32 v242, 16, v215
    v_and_b32 v243, 0xffff0000, v215
    v_pk_fma_f32 v[78:79], v[242:243], v[20:21], v[78:79] op_sel_hi:[1,0,1]
L_mone_32:
    v_cvt_pk_bf16_f32 v100, v72, v73
    v_cvt_pk_bf16_f32 v102, v76, v77
    v_cvt_pk_bf16_f32 v101, v74, v75
    v_cvt_pk_bf16_f32 v103, v78, v79
    s_nop 0
    v_permlane16_swap_b32 v100, v102
    v_permlane16_swap_b32 v101, v103
    buffer_store_dwordx4 v[100:103], v14, s[32:35], s60 offen offset:64 nt
    v_lshlrev_b32 v240, 16, v200
    v_and_b32 v241, 0xffff0000, v200
    v_pk_mul_f32 v[80:81], v[80:81], v[24:25] op_sel_hi:[1,0]
    v_pk_fma_f32 v[80:81], v[240:241], v[26:27], v[80:81] op_sel_hi:[1,0,1]
    v_lshlrev_b32 v242, 16, v201
    v_and_b32 v243, 0xffff0000, v201
    v_pk_mul_f32 v[82:83], v[82:83], v[24:25] op_sel_hi:[1,0]
    v_pk_fma_f32 v[82:83], v[242:243], v[26:27], v[82:83] op_sel_hi:[1,0,1]
    v_lshlrev_b32 v240, 16, v202
    v_and_b32 v241, 0xffff0000, v202
    v_pk_mul_f32 v[84:85], v[84:85], v[24:25] op_sel_hi:[1,0]
    v_pk_fma_f32 v[84:85], v[240:241], v[26:27], v[84:85] op_sel_hi:[1,0,1]
    v_lshlrev_b32 v242, 16, v203
    v_and_b32 v243, 0xffff0000, v203
    v_pk_mul_f32 v[86:87], v[86:87], v[24:25] op_sel_hi:[1,0]
    v_pk_fma_f32 v[86:87], v[242:243], v[26:27], v[86:87] op_sel_hi:[1,0,1]
    s_cbranch_scc1 L_mone_33
    v_lshlrev_b32 v240, 16, v216
    v_and_b32 v241, 0xffff0000, v216
    v_pk_fma_f32 v[80:81], v[240:241], v[20:21], v[80:81] op_sel_hi:[1,0,1]
    v_lshlrev_b32 v242, 16, v217
    v_and_b32 v243, 0xffff0000, v217
    v_pk_fma_f32 v[82:83], v[242:243], v[20:21], v[82:83] op_sel_hi:[1,0,1]
    v_lshlrev_b32 v240, 16, v218
    v_and_b32 v241, 0xffff0000, v218
    v_pk_fma_f32 v[84:85], v[240:241], v[20:21], v[84:85] op_sel_hi:[1,0,1]
    v_lshlrev_b32 v242, 16, v219
    v_and_b32 v243, 0xffff0000, v219
    v_pk_fma_f32 v[86:87], v[242:243], v[20:21], v[86:87] op_sel_hi:[1,0,1]
L_mone_33:
    v_cvt_pk_bf16_f32 v104, v80, v81
    v_cvt_pk_bf16_f32 v106, v84, v85
    v_cvt_pk_bf16_f32 v105, v82, v83
    v_cvt_pk_bf16_f32 v107, v86, v87
    s_nop 0
    v_permlane16_swap_b32 v104, v106
    v_permlane16_swap_b32 v105, v107
    buffer_store_dwordx4 v[104:107], v14, s[32:35], s60 offen offset:128 nt
    v_lshlrev_b32 v240, 16, v204
    v_and_b32 v241, 0xffff0000, v204
    v_pk_mul_f32 v[88:89], v[88:89], v[24:25] op_sel_hi:[1,0]
    v_pk_fma_f32 v[88:89], v[240:241], v[26:27], v[88:89] op_sel_hi:[1,0,1]
    v_lshlrev_b32 v242, 16, v205
    v_and_b32 v243, 0xffff0000, v205
    v_pk_mul_f32 v[90:91], v[90:91], v[24:25] op_sel_hi:[1,0]
    v_pk_fma_f32 v[90:91], v[242:243], v[26:27], v[90:91] op_sel_hi:[1,0,1]
    v_lshlrev_b32 v240, 16, v206
    v_and_b32 v241, 0xffff0000, v206
    v_pk_mul_f32 v[92:93], v[92:93], v[24:25] op_sel_hi:[1,0]
    v_pk_fma_f32 v[92:93], v[240:241], v[26:27], v[92:93] op_sel_hi:[1,0,1]
    v_lshlrev_b32 v242, 16, v207
    v_and_b32 v243, 0xffff0000, v207
    v_pk_mul_f32 v[94:95], v[94:95], v[24:25] op_sel_hi:[1,0]
    v_pk_fma_f32 v[94:95], v[242:243], v[26:27], v[94:95] op_sel_hi:[1,0,1]
    s_cbranch_scc1 L_mone_34
    v_lshlrev_b32 v240, 16, v220
    v_and_b32 v241, 0xffff0000, v220
    v_pk_fma_f32 v[88:89], v[240:241], v[20:21], v[88:89] op_sel_hi:[1,0,1]
    v_lshlrev_b32 v242, 16, v221
    v_and_b32 v243, 0xffff0000, v221
    v_pk_fma_f32 v[90:91], v[242:243], v[20:21], v[90:91] op_sel_hi:[1,0,1]
    v_lshlrev_b32 v240, 16, v222
    v_and_b32 v241, 0xffff0000, v222
    v_pk_fma_f32 v[92:93], v[240:241], v[20:21], v[92:93] op_sel_hi:[1,0,1]
    v_lshlrev_b32 v242, 16, v223
    v_and_b32 v243, 0xffff0000, v223
    v_pk_fma_f32 v[94:95], v[242:243], v[20:21], v[94:95] op_sel_hi:[1,0,1]
L_mone_34:
    v_cvt_pk_bf16_f32 v108, v88, v89
    v_cvt_pk_bf16_f32 v110, v92, v93
    v_cvt_pk_bf16_f32 v109, v90, v91
    v_cvt_pk_bf16_f32 v111, v94, v95
    s_nop 0
    v_permlane16_swap_b32 v108, v110
    v_permlane16_swap_b32 v109, v111
    buffer_store_dwordx4 v[108:111], v14, s[32:35], s60 offen offset:192 nt
    s_cmp_eq_u32 s64, 0
    s_cbranch_scc1 L_h_check
L_fin:
L_end:
    s_endpgm
L_pv_scale:
    v_mul_f32 v64, v24, v64
    v_mul_f32 v65, v24, v65
    v_mul_f32 v66, v24, v66
    v_mul_f32 v67, v24, v67
    v_mul_f32 v68, v24, v68
    v_mul_f32 v69, v24, v69
    v_mul_f32 v70, v24, v70
    v_mul_f32 v71, v24, v71
    v_mfma_f32_16x16x32_bf16 v[64:67], v[160:163], v[60:63], v[64:67]
    v_mul_f32 v72, v24, v72
    v_mul_f32 v73, v24, v73
    v_mul_f32 v74, v24, v74
    v_mul_f32 v75, v24, v75
    v_add_f32 v17, v52, v53
    s_sub_u32 s57, s50, s48
    s_lshl3_add_u32 s57, s57, s6
    v_mfma_f32_16x16x32_bf16 v[68:71], v[164:167], v[60:63], v[68:71]
    v_mul_f32 v76, v24, v76
    v_mul_f32 v77, v24, v77
    v_mul_f32 v78, v24, v78
    v_mul_f32 v79, v24, v79
    v_add_f32 v18, v54, v55
    s_add_u32 s11, s57, s101
    v_mfma_f32_16x16x32_bf16 v[72:75], v[168:171], v[60:63], v[72:75]
    v_mul_f32 v80, v24, v80
    v_mul_f32 v81, v24, v81
    v_mul_f32 v82, v24, v82
    v_mul_f32 v83, v24, v83
    v_add_f32 v19, v56, v57
    s_mov_b32 s6, 0
    v_mfma_f32_16x16x32_bf16 v[76:79], v[172:175], v[60:63], v[76:79]
    v_mul_f32 v84, v24, v84
    v_mul_f32 v85, v24, v85
    v_mul_f32 v86, v24, v86
    v_mul_f32 v87, v24, v87
    v_add_f32 v20, v58, v59
    s_mov_b32 s101, 0
    v_mfma_f32_16x16x32_bf16 v[80:83], v[176:179], v[60:63], v[80:83]
    v_mul_f32 v88, v24, v88
    v_mul_f32 v89, v24, v89
    v_mul_f32 v90, v24, v90
    v_mul_f32 v91, v24, v91
    v_add_f32 v17, v17, v18
    s_add_u32 s57, s48, 2
    s_cmp_eq_u32 s57, s47
    v_mfma_f32_16x16x32_bf16 v[84:87], v[180:183], v[60:63], v[84:87]
    v_mul_f32 v92, v24, v92
    v_mul_f32 v93, v24, v93
    v_mul_f32 v94, v24, v94
    v_mul_f32 v95, v24, v95
    v_add_f32 v19, v19, v20
    s_cselect_b32 s75, s66, 0
    s_and_b32 s18, s4, 2
    v_mfma_f32_16x16x32_bf16 v[88:91], v[184:187], v[60:63], v[88:91]
    v_add_f32 v17, v17, v19
    s_or_b32 s18, s18, s75
    s_add_u32 s48, s48, 1
    v_mfma_f32_16x16x32_bf16 v[92:95], v[188:191], v[60:63], v[92:95]
    v_fma_f32 v5, v5, v24, v17
    s_sub_u32 s57, s48, 1
    s_bitcmp0_b64 s[62:63], s57
    s_cbranch_scc1 L_loop
    s_branch L_piece_end
L_mask:
    s_and_b32 s57, s56, 63
    v_mov_b32 v16, 0xff61b1e6
    s_sub_i32 s58, s57, 0
    v_cmp_gt_i32 vcc, s58, v6
    s_nop 1
    v_cndmask_b32 v52, v16, v52, vcc
    s_sub_i32 s58, s57, 1
    v_cmp_gt_i32 vcc, s58, v6
    s_nop 1
    v_cndmask_b32 v53, v16, v53, vcc
    s_sub_i32 s58, s57, 2
    v_cmp_gt_i32 vcc, s58, v6
    s_nop 1
    v_cndmask_b32 v54, v16, v54, vcc
    s_sub_i32 s58, s57, 3
    v_cmp_gt_i32 vcc, s58, v6
    s_nop 1
    v_cndmask_b32 v55, v16, v55, vcc
    s_sub_i32 s58, s57, 16
    v_cmp_gt_i32 vcc, s58, v6
    s_nop 1
    v_cndmask_b32 v56, v16, v56, vcc
    s_sub_i32 s58, s57, 17
    v_cmp_gt_i32 vcc, s58, v6
    s_nop 1
    v_cndmask_b32 v57, v16, v57, vcc
    s_sub_i32 s58, s57, 18
    v_cmp_gt_i32 vcc, s58, v6
    s_nop 1
    v_cndmask_b32 v58, v16, v58, vcc
    s_sub_i32 s58, s57, 19
    v_cmp_gt_i32 vcc, s58, v6
    s_nop 1
    v_cndmask_b32 v59, v16, v59, vcc
    s_branch L_no_mask
L_claim:
    s_cmp_ge_u32 s48, s15
    s_cbranch_scc1 L_no_claim
    s_bitset1_b32 s4, 0
    s_cmp_lg_u32 s44, 0
    s_cbranch_scc1 L_no_claim
    s_mov_b32 s6, 1
    s_mov_b64 exec, 1
    s_bitcmp1_b32 s48, 0
    s_cbranch_scc1 L_claim_odd
    v_mov_b32 v252, 0x100
    buffer_atomic_add v252, off, s[40:43], s76 sc0
    s_mov_b64 exec, -1
    s_branch L_no_claim
L_claim_odd:
    v_mov_b32 v253, 0x100
    buffer_atomic_add v253, off, s[40:43], s76 sc0
    s_mov_b64 exec, -1
    s_branch L_no_claim
L_sig:
    s_or_b64 s[16:17], s[16:17], s[8:9]
    s_cmp_lg_u32 s44, 0
    s_cbranch_scc1 L_sig_out
    s_add_u32 s6, s6, 1
    s_mov_b64 exec, s[8:9]
    buffer_atomic_add v194, v193, s[40:43], 0 offen sc0
    s_mov_b64 exec, -1
L_sig_out:
    s_mov_b64 s[8:9], 0
    s_branch L_no_sig
L_poll:
    s_cmp_lg_u32 s44, 0
    s_cbranch_scc1 L_no_poll
    buffer_load_dword v12, off, s[40:43], s76 sc1
    s_branch L_no_poll
L_step:
    s_add_u32 s19, s19, 1
    s_add_u32 s3, s3, 2
    s_cmp_eq_u32 s19, 3
    s_cselect_b32 s3, -1, s3
    s_cmp_lg_u32 s44, 0
    s_cbranch_scc1 L_step_ret
    s_cmp_eq_u32 s19, 3
    s_cbranch_scc1 L_bs2_36
    s_add_u32 s6, s6, 1
    v_mov_b32 v196, 0
    s_mov_b64 exec, s[0:1]
    buffer_atomic_or v196, v197, s[36:39], 0 offen sc0
    s_mov_b64 exec, -1
    s_branch L_step_ret
L_bs2_36:
    v_bfe_u32 v196, v196, v200, 16
    v_cmp_gt_u32 vcc, 0x8000, v196
    s_nop 1
    v_cndmask_b32 v198, v196, v195, vcc
    v_and_b32 v198, 0x7fff, v198
    v_or_b32 v199, 0x8000, v198
    v_readlane_b32 s77, v198, 63
    v_lshlrev_b32 v199, v200, v199
    s_not_b64 exec, s[0:1]
    s_nop 0
    v_mov_b32 v198, s77
    s_mov_b64 exec, -1
    s_and_b64 s[78:79], vcc, s[0:1]
    s_cbranch_scc0 L_step_ret
    s_add_u32 s6, s6, 1
    s_mov_b64 exec, s[78:79]
    buffer_atomic_or v199, v197, s[36:39], 0 offen sc0
    s_mov_b64 exec, -1
    s_branch L_step_ret
L_post_special:
    s_waitcnt lgkmcnt(12)
    v_readfirstlane_b32 s57, v18
    s_cmp_eq_u32 s75, 0
    s_cbranch_scc1 L_post_claim
    s_cmp_lt_u32 s19, 3
    s_cbranch_scc1 L_no_load
    s_and_b32 s57, s57, 0xff
    s_cmp_lg_u32 s57, s66
    s_cbranch_scc1 L_repoll
    s_mov_b32 s71, 1
    s_mov_b32 s70, 0
    s_cmp_eq_u32 s65, 0
    s_cbranch_scc1 L_i3done_38
    s_ff1_i32_b32 s57, s65
    s_bitset0_b32 s65, s57
    s_lshl_b32 s59, s57, 4
    s_sub_u32 s59, s59, 210
    s_add_u32 s60, s57, s54
    s_cmp_lt_u32 s57, 16
    s_cselect_b32 s59, s60, s59
    s_add_u32 s59, s59, s54
    s_mul_i32 s59, s59, 17408
    s_add_u32 s59, s59, s73
    buffer_load_dwordx4 v[192:195], v13, s[40:43], s59 offen offset:0 sc1
    buffer_load_dwordx4 v[196:199], v13, s[40:43], s59 offen offset:1024 sc1
    buffer_load_dwordx4 v[200:203], v13, s[40:43], s59 offen offset:2048 sc1
    buffer_load_dwordx4 v[204:207], v13, s[40:43], s59 offen offset:3072 sc1
    s_add_u32 s59, s59, 4096
    buffer_load_dword v28, v15, s[40:43], s59 offen sc1
    s_mov_b32 s70, 1
    s_cmp_eq_u32 s65, 0
    s_cbranch_scc1 L_i3done_38
    s_ff1_i32_b32 s57, s65
    s_bitset0_b32 s65, s57
    s_lshl_b32 s59, s57, 4
    s_sub_u32 s59, s59, 210
    s_add_u32 s60, s57, s54
    s_cmp_lt_u32 s57, 16
    s_cselect_b32 s59, s60, s59
    s_add_u32 s59, s59, s54
    s_mul_i32 s59, s59, 17408
    s_add_u32 s59, s59, s73
    buffer_load_dwordx4 v[208:211], v13, s[40:43], s59 offen offset:0 sc1
    buffer_load_dwordx4 v[212:215], v13, s[40:43], s59 offen offset:1024 sc1
    buffer_load_dwordx4 v[216:219], v13, s[40:43], s59 offen offset:2048 sc1
    buffer_load_dwordx4 v[220:223], v13, s[40:43], s59 offen offset:3072 sc1
    s_add_u32 s59, s59, 4096
    buffer_load_dword v29, v15, s[40:43], s59 offen sc1
    s_mov_b32 s70, 2
    s_cmp_eq_u32 s65, 0
    s_cbranch_scc1 L_i3done_38
    s_ff1_i32_b32 s57, s65
    s_bitset0_b32 s65, s57
    s_lshl_b32 s59, s57, 4
    s_sub_u32 s59, s59, 210
    s_add_u32 s60, s57, s54
    s_cmp_lt_u32 s57, 16
    s_cselect_b32 s59, s60, s59
    s_add_u32 s59, s59, s54
    s_mul_i32 s59, s59, 17408
    s_add_u32 s59, s59, s73
    buffer_load_dwordx4 v[224:227], v13, s[40:43], s59 offen offset:0 sc1
    buffer_load_dwordx4 v[228:231], v13, s[40:43], s59 offen offset:1024 sc1
    buffer_load_dwordx4 v[232:235], v13, s[40:43], s59 offen offset:2048 sc1
    buffer_load_dwordx4 v[236:239], v13, s[40:43], s59 offen offset:3072 sc1
    s_add_u32 s59, s59, 4096
    buffer_load_dword v30, v15, s[40:43], s59 offen sc1
    s_mov_b32 s70, 3
L_i3done_38:
    s_branch L_no_load
L_repoll:
    s_mov_b32 s67, s48
    s_branch L_no_load
L_post_claim:
    v_readfirstlane_b32 s58, v19
    s_cmp_eq_u32 s5, 0x7fffffff
    s_cbranch_scc1 L_more_load
    s_bitcmp1_b32 s48, 0
    s_cselect_b32 s57, s58, s57
    s_bfe_u32 s57, s57, 0x70008
    s_cmp_ge_u32 s57, s53
    s_cbranch_scc1 L_close
    s_add_u32 s47, s47, 1
    s_cmp_lt_u32 s47, s52
    s_cbranch_scc1 L_more_load
L_close:
    s_mov_b32 s5, 0x7fffffff
    s_sub_u32 s57, s47, 1
    s_bitset1_b64 s[62:63], s57
    s_cmp_eq_u32 s66, 0
    s_cbranch_scc1 L_more_load
    s_sub_u32 s67, s47, 2
    s_branch L_more_load
L_bar_special:
    s_cmp_eq_u32 s75, 0
    s_cbranch_scc1 L_bar_claim
    s_cmp_lg_u32 s44, 0
    s_cbranch_scc1 L_bar2
    v_subrev_u32 v12, s77, v12
    ds_write_b32 v251, v12 offset:12
    s_waitcnt lgkmcnt(0)
L_bar2:
    s_barrier
    ds_read_b32 v18, v251 offset:12
    s_branch L_after_bar
L_bar_claim:
    s_cmp_lg_u32 s44, 0
    s_cbranch_scc1 L_bar_cl
    s_mov_b64 exec, 1
    s_bitcmp1_b32 s48, 0
    s_cbranch_scc1 L_bar_odd
    v_subrev_u32 v252, s77, v252
    ds_write_b32 v251, v252
    s_branch L_bar_w
L_bar_odd:
    v_subrev_u32 v253, s77, v253
    ds_write_b32 v251, v253 offset:4
L_bar_w:
    s_mov_b64 exec, -1
    s_waitcnt lgkmcnt(0)
L_bar_cl:
    s_barrier
    ds_read_b64 v[18:19], v251
    s_branch L_after_bar
L_wait_other:
    s_cmp_gt_u32 s11, 16
    s_cbranch_scc1 L_wait_some
    s_waitcnt vmcnt(0)
    s_branch L_waited
L_wait_some:
    s_cmp_lg_u32 s11, 25
    s_cbranch_scc1 L_wv_39
    s_waitcnt vmcnt(9)
    s_branch L_waited
L_wv_39:
    s_cmp_lt_u32 s11, 33
    s_cbranch_scc1 L_wv_40
    s_waitcnt vmcnt(17)
    s_branch L_waited
L_wv_40:
    s_cmp_lt_u32 s11, 29
    s_cbranch_scc1 L_wv_41
    s_waitcnt vmcnt(13)
    s_branch L_waited
L_wv_41:
    s_cmp_lt_u32 s11, 28
    s_cbranch_scc1 L_wv_42
    s_waitcnt vmcnt(12)
    s_branch L_waited
L_wv_42:
    s_cmp_lt_u32 s11, 26
    s_cbranch_scc1 L_wv_43
    s_waitcnt vmcnt(10)
    s_branch L_waited
L_wv_43:
    s_cmp_lt_u32 s11, 18
    s_cbranch_scc1 L_wv_44
    s_waitcnt vmcnt(2)
    s_branch L_waited
L_wv_44:
    s_waitcnt vmcnt(1)
    s_branch L_waited
L_merge_many:
    s_waitcnt vmcnt(0)
    s_cmp_le_u32 s70, 0
    s_cbranch_scc1 L_m3done_45
    v_max_f32 v16, v4, v28
    v_sub_f32 v24, v4, v16
    v_sub_f32 v26, v28, v16
    v_exp_f32 v24, v24
    v_exp_f32 v26, v26
    v_mov_b32 v4, v16
    v_fma_f32 v5, v5, v24, v26
    v_lshlrev_b32 v240, 16, v192
    v_and_b32 v241, 0xffff0000, v192
    v_pk_mul_f32 v[64:65], v[64:65], v[24:25] op_sel_hi:[1,0]
    v_pk_fma_f32 v[64:65], v[240:241], v[26:27], v[64:65] op_sel_hi:[1,0,1]
    v_lshlrev_b32 v240, 16, v193
    v_and_b32 v241, 0xffff0000, v193
    v_pk_mul_f32 v[66:67], v[66:67], v[24:25] op_sel_hi:[1,0]
    v_pk_fma_f32 v[66:67], v[240:241], v[26:27], v[66:67] op_sel_hi:[1,0,1]
    v_lshlrev_b32 v240, 16, v194
    v_and_b32 v241, 0xffff0000, v194
    v_pk_mul_f32 v[68:69], v[68:69], v[24:25] op_sel_hi:[1,0]
    v_pk_fma_f32 v[68:69], v[240:241], v[26:27], v[68:69] op_sel_hi:[1,0,1]
    v_lshlrev_b32 v240, 16, v195
    v_and_b32 v241, 0xffff0000, v195
    v_pk_mul_f32 v[70:71], v[70:71], v[24:25] op_sel_hi:[1,0]
    v_pk_fma_f32 v[70:71], v[240:241], v[26:27], v[70:71] op_sel_hi:[1,0,1]
    v_lshlrev_b32 v240, 16, v196
    v_and_b32 v241, 0xffff0000, v196
    v_pk_mul_f32 v[72:73], v[72:73], v[24:25] op_sel_hi:[1,0]
    v_pk_fma_f32 v[72:73], v[240:241], v[26:27], v[72:73] op_sel_hi:[1,0,1]
    v_lshlrev_b32 v240, 16, v197
    v_and_b32 v241, 0xffff0000, v197
    v_pk_mul_f32 v[74:75], v[74:75], v[24:25] op_sel_hi:[1,0]
    v_pk_fma_f32 v[74:75], v[240:241], v[26:27], v[74:75] op_sel_hi:[1,0,1]
    v_lshlrev_b32 v240, 16, v198
    v_and_b32 v241, 0xffff0000, v198
    v_pk_mul_f32 v[76:77], v[76:77], v[24:25] op_sel_hi:[1,0]
    v_pk_fma_f32 v[76:77], v[240:241], v[26:27], v[76:77] op_sel_hi:[1,0,1]
    v_lshlrev_b32 v240, 16, v199
    v_and_b32 v241, 0xffff0000, v199
    v_pk_mul_f32 v[78:79], v[78:79], v[24:25] op_sel_hi:[1,0]
    v_pk_fma_f32 v[78:79], v[240:241], v[26:27], v[78:79] op_sel_hi:[1,0,1]
    v_lshlrev_b32 v240, 16, v200
    v_and_b32 v241, 0xffff0000, v200
    v_pk_mul_f32 v[80:81], v[80:81], v[24:25] op_sel_hi:[1,0]
    v_pk_fma_f32 v[80:81], v[240:241], v[26:27], v[80:81] op_sel_hi:[1,0,1]
    v_lshlrev_b32 v240, 16, v201
    v_and_b32 v241, 0xffff0000, v201
    v_pk_mul_f32 v[82:83], v[82:83], v[24:25] op_sel_hi:[1,0]
    v_pk_fma_f32 v[82:83], v[240:241], v[26:27], v[82:83] op_sel_hi:[1,0,1]
    v_lshlrev_b32 v240, 16, v202
    v_and_b32 v241, 0xffff0000, v202
    v_pk_mul_f32 v[84:85], v[84:85], v[24:25] op_sel_hi:[1,0]
    v_pk_fma_f32 v[84:85], v[240:241], v[26:27], v[84:85] op_sel_hi:[1,0,1]
    v_lshlrev_b32 v240, 16, v203
    v_and_b32 v241, 0xffff0000, v203
    v_pk_mul_f32 v[86:87], v[86:87], v[24:25] op_sel_hi:[1,0]
    v_pk_fma_f32 v[86:87], v[240:241], v[26:27], v[86:87] op_sel_hi:[1,0,1]
    v_lshlrev_b32 v240, 16, v204
    v_and_b32 v241, 0xffff0000, v204
    v_pk_mul_f32 v[88:89], v[88:89], v[24:25] op_sel_hi:[1,0]
    v_pk_fma_f32 v[88:89], v[240:241], v[26:27], v[88:89] op_sel_hi:[1,0,1]
    v_lshlrev_b32 v240, 16, v205
    v_and_b32 v241, 0xffff0000, v205
    v_pk_mul_f32 v[90:91], v[90:91], v[24:25] op_sel_hi:[1,0]
    v_pk_fma_f32 v[90:91], v[240:241], v[26:27], v[90:91] op_sel_hi:[1,0,1]
    v_lshlrev_b32 v240, 16, v206
    v_and_b32 v241, 0xffff0000, v206
    v_pk_mul_f32 v[92:93], v[92:93], v[24:25] op_sel_hi:[1,0]
    v_pk_fma_f32 v[92:93], v[240:241], v[26:27], v[92:93] op_sel_hi:[1,0,1]
    v_lshlrev_b32 v240, 16, v207
    v_and_b32 v241, 0xffff0000, v207
    v_pk_mul_f32 v[94:95], v[94:95], v[24:25] op_sel_hi:[1,0]
    v_pk_fma_f32 v[94:95], v[240:241], v[26:27], v[94:95] op_sel_hi:[1,0,1]
    s_cmp_le_u32 s70, 1
    s_cbranch_scc1 L_m3done_45
    v_max_f32 v16, v4, v29
    v_sub_f32 v24, v4, v16
    v_sub_f32 v26, v29, v16
    v_exp_f32 v24, v24
    v_exp_f32 v26, v26
    v_mov_b32 v4, v16
    v_fma_f32 v5, v5, v24, v26
    v_lshlrev_b32 v240, 16, v208
    v_and_b32 v241, 0xffff0000, v208
    v_pk_mul_f32 v[64:65], v[64:65], v[24:25] op_sel_hi:[1,0]
    v_pk_fma_f32 v[64:65], v[240:241], v[26:27], v[64:65] op_sel_hi:[1,0,1]
    v_lshlrev_b32 v240, 16, v209
    v_and_b32 v241, 0xffff0000, v209
    v_pk_mul_f32 v[66:67], v[66:67], v[24:25] op_sel_hi:[1,0]
    v_pk_fma_f32 v[66:67], v[240:241], v[26:27], v[66:67] op_sel_hi:[1,0,1]
    v_lshlrev_b32 v240, 16, v210
    v_and_b32 v241, 0xffff0000, v210
    v_pk_mul_f32 v[68:69], v[68:69], v[24:25] op_sel_hi:[1,0]
    v_pk_fma_f32 v[68:69], v[240:241], v[26:27], v[68:69] op_sel_hi:[1,0,1]
    v_lshlrev_b32 v240, 16, v211
    v_and_b32 v241, 0xffff0000, v211
    v_pk_mul_f32 v[70:71], v[70:71], v[24:25] op_sel_hi:[1,0]
    v_pk_fma_f32 v[70:71], v[240:241], v[26:27], v[70:71] op_sel_hi:[1,0,1]
    v_lshlrev_b32 v240, 16, v212
    v_and_b32 v241, 0xffff0000, v212
    v_pk_mul_f32 v[72:73], v[72:73], v[24:25] op_sel_hi:[1,0]
    v_pk_fma_f32 v[72:73], v[240:241], v[26:27], v[72:73] op_sel_hi:[1,0,1]
    v_lshlrev_b32 v240, 16, v213
    v_and_b32 v241, 0xffff0000, v213
    v_pk_mul_f32 v[74:75], v[74:75], v[24:25] op_sel_hi:[1,0]
    v_pk_fma_f32 v[74:75], v[240:241], v[26:27], v[74:75] op_sel_hi:[1,0,1]
    v_lshlrev_b32 v240, 16, v214
    v_and_b32 v241, 0xffff0000, v214
    v_pk_mul_f32 v[76:77], v[76:77], v[24:25] op_sel_hi:[1,0]
    v_pk_fma_f32 v[76:77], v[240:241], v[26:27], v[76:77] op_sel_hi:[1,0,1]
    v_lshlrev_b32 v240, 16, v215
    v_and_b32 v241, 0xffff0000, v215
    v_pk_mul_f32 v[78:79], v[78:79], v[24:25] op_sel_hi:[1,0]
    v_pk_fma_f32 v[78:79], v[240:241], v[26:27], v[78:79] op_sel_hi:[1,0,1]
    v_lshlrev_b32 v240, 16, v216
    v_and_b32 v241, 0xffff0000, v216
    v_pk_mul_f32 v[80:81], v[80:81], v[24:25] op_sel_hi:[1,0]
    v_pk_fma_f32 v[80:81], v[240:241], v[26:27], v[80:81] op_sel_hi:[1,0,1]
    v_lshlrev_b32 v240, 16, v217
    v_and_b32 v241, 0xffff0000, v217
    v_pk_mul_f32 v[82:83], v[82:83], v[24:25] op_sel_hi:[1,0]
    v_pk_fma_f32 v[82:83], v[240:241], v[26:27], v[82:83] op_sel_hi:[1,0,1]
    v_lshlrev_b32 v240, 16, v218
    v_and_b32 v241, 0xffff0000, v218
    v_pk_mul_f32 v[84:85], v[84:85], v[24:25] op_sel_hi:[1,0]
    v_pk_fma_f32 v[84:85], v[240:241], v[26:27], v[84:85] op_sel_hi:[1,0,1]
    v_lshlrev_b32 v240, 16, v219
    v_and_b32 v241, 0xffff0000, v219
    v_pk_mul_f32 v[86:87], v[86:87], v[24:25] op_sel_hi:[1,0]
    v_pk_fma_f32 v[86:87], v[240:241], v[26:27], v[86:87] op_sel_hi:[1,0,1]
    v_lshlrev_b32 v240, 16, v220
    v_and_b32 v241, 0xffff0000, v220
    v_pk_mul_f32 v[88:89], v[88:89], v[24:25] op_sel_hi:[1,0]
    v_pk_fma_f32 v[88:89], v[240:241], v[26:27], v[88:89] op_sel_hi:[1,0,1]
    v_lshlrev_b32 v240, 16, v221
    v_and_b32 v241, 0xffff0000, v221
    v_pk_mul_f32 v[90:91], v[90:91], v[24:25] op_sel_hi:[1,0]
    v_pk_fma_f32 v[90:91], v[240:241], v[26:27], v[90:91] op_sel_hi:[1,0,1]
    v_lshlrev_b32 v240, 16, v222
    v_and_b32 v241, 0xffff0000, v222
    v_pk_mul_f32 v[92:93], v[92:93], v[24:25] op_sel_hi:[1,0]
    v_pk_fma_f32 v[92:93], v[240:241], v[26:27], v[92:93] op_sel_hi:[1,0,1]
    v_lshlrev_b32 v240, 16, v223
    v_and_b32 v241, 0xffff0000, v223
    v_pk_mul_f32 v[94:95], v[94:95], v[24:25] op_sel_hi:[1,0]
    v_pk_fma_f32 v[94:95], v[240:241], v[26:27], v[94:95] op_sel_hi:[1,0,1]
    s_cmp_le_u32 s70, 2
    s_cbranch_scc1 L_m3done_45
    v_max_f32 v16, v4, v30
    v_sub_f32 v24, v4, v16
    v_sub_f32 v26, v30, v16
    v_exp_f32 v24, v24
    v_exp_f32 v26, v26
    v_mov_b32 v4, v16
    v_fma_f32 v5, v5, v24, v26
    v_lshlrev_b32 v240, 16, v224
    v_and_b32 v241, 0xffff0000, v224
    v_pk_mul_f32 v[64:65], v[64:65], v[24:25] op_sel_hi:[1,0]
    v_pk_fma_f32 v[64:65], v[240:241], v[26:27], v[64:65] op_sel_hi:[1,0,1]
    v_lshlrev_b32 v240, 16, v225
    v_and_b32 v241, 0xffff0000, v225
    v_pk_mul_f32 v[66:67], v[66:67], v[24:25] op_sel_hi:[1,0]
    v_pk_fma_f32 v[66:67], v[240:241], v[26:27], v[66:67] op_sel_hi:[1,0,1]
    v_lshlrev_b32 v240, 16, v226
    v_and_b32 v241, 0xffff0000, v226
    v_pk_mul_f32 v[68:69], v[68:69], v[24:25] op_sel_hi:[1,0]
    v_pk_fma_f32 v[68:69], v[240:241], v[26:27], v[68:69] op_sel_hi:[1,0,1]
    v_lshlrev_b32 v240, 16, v227
    v_and_b32 v241, 0xffff0000, v227
    v_pk_mul_f32 v[70:71], v[70:71], v[24:25] op_sel_hi:[1,0]
    v_pk_fma_f32 v[70:71], v[240:241], v[26:27], v[70:71] op_sel_hi:[1,0,1]
    v_lshlrev_b32 v240, 16, v228
    v_and_b32 v241, 0xffff0000, v228
    v_pk_mul_f32 v[72:73], v[72:73], v[24:25] op_sel_hi:[1,0]
    v_pk_fma_f32 v[72:73], v[240:241], v[26:27], v[72:73] op_sel_hi:[1,0,1]
    v_lshlrev_b32 v240, 16, v229
    v_and_b32 v241, 0xffff0000, v229
    v_pk_mul_f32 v[74:75], v[74:75], v[24:25] op_sel_hi:[1,0]
    v_pk_fma_f32 v[74:75], v[240:241], v[26:27], v[74:75] op_sel_hi:[1,0,1]
    v_lshlrev_b32 v240, 16, v230
    v_and_b32 v241, 0xffff0000, v230
    v_pk_mul_f32 v[76:77], v[76:77], v[24:25] op_sel_hi:[1,0]
    v_pk_fma_f32 v[76:77], v[240:241], v[26:27], v[76:77] op_sel_hi:[1,0,1]
    v_lshlrev_b32 v240, 16, v231
    v_and_b32 v241, 0xffff0000, v231
    v_pk_mul_f32 v[78:79], v[78:79], v[24:25] op_sel_hi:[1,0]
    v_pk_fma_f32 v[78:79], v[240:241], v[26:27], v[78:79] op_sel_hi:[1,0,1]
    v_lshlrev_b32 v240, 16, v232
    v_and_b32 v241, 0xffff0000, v232
    v_pk_mul_f32 v[80:81], v[80:81], v[24:25] op_sel_hi:[1,0]
    v_pk_fma_f32 v[80:81], v[240:241], v[26:27], v[80:81] op_sel_hi:[1,0,1]
    v_lshlrev_b32 v240, 16, v233
    v_and_b32 v241, 0xffff0000, v233
    v_pk_mul_f32 v[82:83], v[82:83], v[24:25] op_sel_hi:[1,0]
    v_pk_fma_f32 v[82:83], v[240:241], v[26:27], v[82:83] op_sel_hi:[1,0,1]
    v_lshlrev_b32 v240, 16, v234
    v_and_b32 v241, 0xffff0000, v234
    v_pk_mul_f32 v[84:85], v[84:85], v[24:25] op_sel_hi:[1,0]
    v_pk_fma_f32 v[84:85], v[240:241], v[26:27], v[84:85] op_sel_hi:[1,0,1]
    v_lshlrev_b32 v240, 16, v235
    v_and_b32 v241, 0xffff0000, v235
    v_pk_mul_f32 v[86:87], v[86:87], v[24:25] op_sel_hi:[1,0]
    v_pk_fma_f32 v[86:87], v[240:241], v[26:27], v[86:87] op_sel_hi:[1,0,1]
    v_lshlrev_b32 v240, 16, v236
    v_and_b32 v241, 0xffff0000, v236
    v_pk_mul_f32 v[88:89], v[88:89], v[24:25] op_sel_hi:[1,0]
    v_pk_fma_f32 v[88:89], v[240:241], v[26:27], v[88:89] op_sel_hi:[1,0,1]
    v_lshlrev_b32 v240, 16, v237
    v_and_b32 v241, 0xffff0000, v237
    v_pk_mul_f32 v[90:91], v[90:91], v[24:25] op_sel_hi:[1,0]
    v_pk_fma_f32 v[90:91], v[240:241], v[26:27], v[90:91] op_sel_hi:[1,0,1]
    v_lshlrev_b32 v240, 16, v238
    v_and_b32 v241, 0xffff0000, v238
    v_pk_mul_f32 v[92:93], v[92:93], v[24:25] op_sel_hi:[1,0]
    v_pk_fma_f32 v[92:93], v[240:241], v[26:27], v[92:93] op_sel_hi:[1,0,1]
    v_lshlrev_b32 v240, 16, v239
    v_and_b32 v241, 0xffff0000, v239
    v_pk_mul_f32 v[94:95], v[94:95], v[24:25] op_sel_hi:[1,0]
    v_pk_fma_f32 v[94:95], v[240:241], v[26:27], v[94:95] op_sel_hi:[1,0,1]
L_m3done_45:
    s_cmp_lg_u32 s65, 0
    s_cbranch_scc1 L_combine
L_output:
    v_rcp_f32 v24, v5
    s_lshl_b32 s60, s54, 17
    s_add_u32 s60, s60, s72
    v_pk_mul_f32 v[240:241], v[64:65], v[24:25] op_sel_hi:[1,0]
    v_cvt_pk_bf16_f32 v96, v240, v241
    v_pk_mul_f32 v[242:243], v[66:67], v[24:25] op_sel_hi:[1,0]
    v_cvt_pk_bf16_f32 v97, v242, v243
    v_pk_mul_f32 v[240:241], v[68:69], v[24:25] op_sel_hi:[1,0]
    v_cvt_pk_bf16_f32 v98, v240, v241
    v_pk_mul_f32 v[242:243], v[70:71], v[24:25] op_sel_hi:[1,0]
    v_cvt_pk_bf16_f32 v99, v242, v243
    s_nop 0
    v_permlane16_swap_b32 v96, v98
    v_permlane16_swap_b32 v97, v99
    v_pk_mul_f32 v[240:241], v[72:73], v[24:25] op_sel_hi:[1,0]
    v_cvt_pk_bf16_f32 v100, v240, v241
    v_pk_mul_f32 v[242:243], v[74:75], v[24:25] op_sel_hi:[1,0]
    v_cvt_pk_bf16_f32 v101, v242, v243
    v_pk_mul_f32 v[240:241], v[76:77], v[24:25] op_sel_hi:[1,0]
    v_cvt_pk_bf16_f32 v102, v240, v241
    v_pk_mul_f32 v[242:243], v[78:79], v[24:25] op_sel_hi:[1,0]
    v_cvt_pk_bf16_f32 v103, v242, v243
    buffer_store_dwordx4 v[96:99], v14, s[32:35], s60 offen offset:0 nt
    v_permlane16_swap_b32 v100, v102
    v_permlane16_swap_b32 v101, v103
    v_pk_mul_f32 v[240:241], v[80:81], v[24:25] op_sel_hi:[1,0]
    v_cvt_pk_bf16_f32 v104, v240, v241
    v_pk_mul_f32 v[242:243], v[82:83], v[24:25] op_sel_hi:[1,0]
    v_cvt_pk_bf16_f32 v105, v242, v243
    v_pk_mul_f32 v[240:241], v[84:85], v[24:25] op_sel_hi:[1,0]
    v_cvt_pk_bf16_f32 v106, v240, v241
    v_pk_mul_f32 v[242:243], v[86:87], v[24:25] op_sel_hi:[1,0]
    v_cvt_pk_bf16_f32 v107, v242, v243
    buffer_store_dwordx4 v[100:103], v14, s[32:35], s60 offen offset:64 nt
    v_permlane16_swap_b32 v104, v106
    v_permlane16_swap_b32 v105, v107
    v_pk_mul_f32 v[240:241], v[88:89], v[24:25] op_sel_hi:[1,0]
    v_cvt_pk_bf16_f32 v108, v240, v241
    v_pk_mul_f32 v[242:243], v[90:91], v[24:25] op_sel_hi:[1,0]
    v_cvt_pk_bf16_f32 v109, v242, v243
    v_pk_mul_f32 v[240:241], v[92:93], v[24:25] op_sel_hi:[1,0]
    v_cvt_pk_bf16_f32 v110, v240, v241
    v_pk_mul_f32 v[242:243], v[94:95], v[24:25] op_sel_hi:[1,0]
    v_cvt_pk_bf16_f32 v111, v242, v243
    buffer_store_dwordx4 v[104:107], v14, s[32:35], s60 offen offset:128 nt
    v_permlane16_swap_b32 v108, v110
    v_permlane16_swap_b32 v109, v111
    s_nop 0
    buffer_store_dwordx4 v[108:111], v14, s[32:35], s60 offen offset:192 nt
    s_nop 1
    s_branch L_h_check
L_ldslow_1:
    v_bfrev_b32 v242, 1
    s_sub_i32 s60, s58, 0
    v_cmp_gt_i32 vcc, s60, v7
    s_nop 1
    v_cndmask_b32 v243, v242, v32, vcc
    v_cndmask_b32 v247, v242, v36, vcc
    s_sub_i32 s60, s58, 2
    v_cmp_gt_i32 vcc, s60, v7
    s_nop 1
    v_cndmask_b32 v244, v242, v33, vcc
    v_cndmask_b32 v248, v242, v37, vcc
    s_sub_i32 s60, s58, 4
    v_cmp_gt_i32 vcc, s60, v7
    s_nop 1
    v_cndmask_b32 v245, v242, v34, vcc
    v_cndmask_b32 v249, v242, v38, vcc
    s_sub_i32 s60, s58, 6
    v_cmp_gt_i32 vcc, s60, v7
    s_nop 1
    v_cndmask_b32 v246, v242, v35, vcc
    v_cndmask_b32 v250, v242, v39, vcc
    buffer_load_dwordx4 v243, s[20:23], s57 offen offset:0 nt lds
    buffer_load_dwordx4 v244, s[20:23], s57 offen offset:1024 nt lds
    buffer_load_dwordx4 v245, s[20:23], s57 offen offset:2048 nt lds
    buffer_load_dwordx4 v246, s[20:23], s57 offen offset:3072 nt lds
    s_mov_b32 m0, s59
    s_nop 0
    buffer_load_dwordx4 v247, s[24:27], s57 offen offset:0 nt lds
    buffer_load_dwordx4 v248, s[24:27], s57 offen offset:1024 nt lds
    buffer_load_dwordx4 v249, s[24:27], s57 offen offset:2048 nt lds
    buffer_load_dwordx4 v250, s[24:27], s57 offen offset:3072 nt lds
    s_branch L_ldgo_2
L_general:
    s_waitcnt vmcnt(0)
    s_mov_b32 s77, 0
    v_mov_b32 v11, v192
    v_and_b32 v52, 15, v0
    v_add_u32 v53, 1, v52
    v_cmp_gt_i32 vcc, 1, v11
    v_min_i32 v11, 0x800, v11
    v_mov_b32 v21, 0x2800
    v_cndmask_b32 v11, v11, v21, vcc
    v_and_b32 v21, 0xfff, v11
    v_add_u32 v21, 31, v21
    v_lshrrev_b32 v54, 5, v21
    v_mov_b32 v21, v54
    s_nop 1
    v_add_u32_dpp v21, v21, v21 row_shr:1 row_mask:0xf bank_mask:0xf bound_ctrl:1
    s_nop 1
    v_add_u32_dpp v21, v21, v21 row_shr:2 row_mask:0xf bank_mask:0xf bound_ctrl:1
    s_nop 1
    v_add_u32_dpp v21, v21, v21 row_shr:4 row_mask:0xf bank_mask:0xf bound_ctrl:1
    s_nop 1
    v_add_u32_dpp v21, v21, v21 row_shr:8 row_mask:0xf bank_mask:0xf bound_ctrl:1
    s_nop 0
    v_readlane_b32 s18, v21, 15
    s_nop 1
    s_lshr_b32 s57, s18, 4
    s_and_b32 s58, s18, 15
    v_cmp_lt_u32 vcc, s57, v54
    s_nop 0
    s_and_b32 s59, vcc_lo, 0xffff
    s_bcnt1_i32_b32 s60, s59
    v_lshlrev_b32_e64 v53, v52, 1
    v_add_u32 v53, -1, v53
    v_and_b32 v53, s59, v53
    v_bcnt_u32_b32 v53, v53, 0
    v_sub_u32 v52, v52, v53
    v_add_u32 v52, s60, v52
    v_cndmask_b32 v52, v52, v53, vcc
    v_cmp_gt_u32 vcc, s58, v52
    v_mov_b32 v52, s57
    s_nop 0
    v_addc_co_u32 v52, vcc, 0, v52, vcc
    s_branch L_shares
L_list:
    s_lshr_b32 s57, s44, 1
    v_lshlrev_b32 v240, 7, v22
    v_lshl_add_u32 v240, v21, 1, v240
    v_add_lshl_u32 v240, v240, s57, 2
    s_nop 0
    global_load_dword v2, v240, s[12:13]
    s_add_u32 m0, s61, 98304
    s_lshl_b32 s60, s54, 17
    v_xor_b32 v243, 32, v8
    v_xor_b32 v244, 64, v8
    v_xor_b32 v245, 96, v8
    buffer_load_dwordx4 v8, s[28:31], s60 offen offset:0 lds
    buffer_load_dwordx4 v243, s[28:31], s60 offen offset:1024 lds
    buffer_load_dwordx4 v244, s[28:31], s60 offen offset:2048 lds
    buffer_load_dwordx4 v245, s[28:31], s60 offen offset:3072 lds
    s_waitcnt vmcnt(4) lgkmcnt(0)
    s_branch L_listed
L_pro_load:
    v_readlane_b32 s57, v2, s50
    v_readlane_b32 s58, v1, s50
    s_add_u32 s59, s51, s61
    s_mov_b32 m0, s59
    s_lshl_b32 s57, s57, 16
    s_and_b32 s58, s58, 63
    s_add_u32 s59, s59, 16384
    s_cmp_lt_u32 s58, 32
    s_cbranch_scc1 L_ldslow_46
    buffer_load_dwordx4 v32, s[20:23], s57 offen offset:0 nt lds
    buffer_load_dwordx4 v33, s[20:23], s57 offen offset:1024 nt lds
    buffer_load_dwordx4 v34, s[20:23], s57 offen offset:2048 nt lds
    buffer_load_dwordx4 v35, s[20:23], s57 offen offset:3072 nt lds
    s_mov_b32 m0, s59
    s_nop 0
    buffer_load_dwordx4 v36, s[24:27], s57 offen offset:0 nt lds
    buffer_load_dwordx4 v37, s[24:27], s57 offen offset:1024 nt lds
    buffer_load_dwordx4 v38, s[24:27], s57 offen offset:2048 nt lds
    buffer_load_dwordx4 v39, s[24:27], s57 offen offset:3072 nt lds
L_ldgo_47:
    s_add_u32 s50, s50, 1
    s_add_u32 s51, s51, 32768
    s_add_u32 s68, s68, 1
    s_cmp_eq_u32 s51, 98304
    s_cselect_b32 s51, 0, s51
    s_min_u32 s57, s47, 2
    s_cmp_lt_u32 s50, s57
    s_cbranch_scc1 L_pro_load
    s_branch L_pro_loaded
L_ldslow_7:
    v_bfrev_b32 v242, 1
    s_sub_i32 s60, s58, 0
    v_cmp_gt_i32 vcc, s60, v7
    s_nop 1
    v_cndmask_b32 v243, v242, v32, vcc
    v_cndmask_b32 v247, v242, v36, vcc
    s_sub_i32 s60, s58, 2
    v_cmp_gt_i32 vcc, s60, v7
    s_nop 1
    v_cndmask_b32 v244, v242, v33, vcc
    v_cndmask_b32 v248, v242, v37, vcc
    s_sub_i32 s60, s58, 4
    v_cmp_gt_i32 vcc, s60, v7
    s_nop 1
    v_cndmask_b32 v245, v242, v34, vcc
    v_cndmask_b32 v249, v242, v38, vcc
    s_sub_i32 s60, s58, 6
    v_cmp_gt_i32 vcc, s60, v7
    s_nop 1
    v_cndmask_b32 v246, v242, v35, vcc
    v_cndmask_b32 v250, v242, v39, vcc
    buffer_load_dwordx4 v243, s[20:23], s57 offen offset:0 nt lds
    buffer_load_dwordx4 v244, s[20:23], s57 offen offset:1024 nt lds
    buffer_load_dwordx4 v245, s[20:23], s57 offen offset:2048 nt lds
    buffer_load_dwordx4 v246, s[20:23], s57 offen offset:3072 nt lds
    s_mov_b32 m0, s59
    s_nop 0
    buffer_load_dwordx4 v247, s[24:27], s57 offen offset:0 nt lds
    buffer_load_dwordx4 v248, s[24:27], s57 offen offset:1024 nt lds
    buffer_load_dwordx4 v249, s[24:27], s57 offen offset:2048 nt lds
    buffer_load_dwordx4 v250, s[24:27], s57 offen offset:3072 nt lds
    s_branch L_ldgo_8
L_ldslow_46:
    v_bfrev_b32 v242, 1
    s_sub_i32 s60, s58, 0
    v_cmp_gt_i32 vcc, s60, v7
    s_nop 1
    v_cndmask_b32 v243, v242, v32, vcc
    v_cndmask_b32 v247, v242, v36, vcc
    s_sub_i32 s60, s58, 2
    v_cmp_gt_i32 vcc, s60, v7
    s_nop 1
    v_cndmask_b32 v244, v242, v33, vcc
    v_cndmask_b32 v248, v242, v37, vcc
    s_sub_i32 s60, s58, 4
    v_cmp_gt_i32 vcc, s60, v7
    s_nop 1
    v_cndmask_b32 v245, v242, v34, vcc
    v_cndmask_b32 v249, v242, v38, vcc
    s_sub_i32 s60, s58, 6
    v_cmp_gt_i32 vcc, s60, v7
    s_nop 1
    v_cndmask_b32 v246, v242, v35, vcc
    v_cndmask_b32 v250, v242, v39, vcc
    buffer_load_dwordx4 v243, s[20:23], s57 offen offset:0 nt lds
    buffer_load_dwordx4 v244, s[20:23], s57 offen offset:1024 nt lds
    buffer_load_dwordx4 v245, s[20:23], s57 offen offset:2048 nt lds
    buffer_load_dwordx4 v246, s[20:23], s57 offen offset:3072 nt lds
    s_mov_b32 m0, s59
    s_nop 0
    buffer_load_dwordx4 v247, s[24:27], s57 offen offset:0 nt lds
    buffer_load_dwordx4 v248, s[24:27], s57 offen offset:1024 nt lds
    buffer_load_dwordx4 v249, s[24:27], s57 offen offset:2048 nt lds
    buffer_load_dwordx4 v250, s[24:27], s57 offen offset:3072 nt lds
    s_branch L_ldgo_47
.section .rodata,"a"
.p2align 6
.amdhsa_kernel standalone__paged_block_table_kv_pagedattention__sampling_kernel
  .amdhsa_next_free_vgpr 320
  .amdhsa_next_free_sgpr 102
  .amdhsa_accum_offset 256
  .amdhsa_group_segment_fixed_size 0
  .amdhsa_kernarg_size 64
  .amdhsa_user_sgpr_count 2
  .amdhsa_user_sgpr_kernarg_segment_ptr 1
  .amdhsa_system_sgpr_workgroup_id_x 1
.end_amdhsa_kernel
```
